```python
import torch

def _softmax(x, axis=-1):
    return torch.softmax(x, dim=axis)
def _gelu(x):
    return torch.nn.functional.gelu(x, approximate="tanh")
def _silu(x):
    return torch.nn.functional.silu(x)
def _sigmoid(x):
    return torch.sigmoid(x)
def _layernorm(x, axis=-1, eps=1e-5):
    m = x.mean(dim=axis, keepdim=True)
    v = x.var(dim=axis, keepdim=True, unbiased=False)
    return (x - m) / torch.sqrt(v + eps)
def _scatter_add(tgt, idx, src, axis=0):
    return tgt.clone().index_add_(axis, idx, src)
def _segment_sum(src, seg, n):
    out = torch.zeros((n,) + src.shape[1:], dtype=src.dtype)
    return out.index_add_(0, seg, src)
def _pad(x, pw):
    flat = tuple(v for pair in reversed(pw) for v in pair)
    return torch.nn.functional.pad(x, flat)

kernel_name = 'standalone__deep_cross_xdeepfm__recsys'

def setup_inputs():

    _w = (lambda a: (lambda t: t.to(torch.bfloat16) if t.is_floating_point() else t)(torch.as_tensor(a)))
    B, F, D, L = 16384, 26, 16, 3
    V = min(1000, 100000)
    Din = F * D
    return {
        "idx": _w((lambda lo, hi, *s: torch.randint(lo, hi, s))(0, V, B, F).to(torch.int64)),
        "table": _w((lambda *s: torch.randn(*s, dtype=torch.bfloat16) * 0.8)(V, D)),
        "ws_cin": _w((lambda *s: torch.randn(*s, dtype=torch.bfloat16) * 0.2)(L, F, F, F) * (1.0 / F)),
        "w_cin_out": _w((lambda *s: torch.randn(*s, dtype=torch.bfloat16) * 0.2)(L * F) * ((L * F) ** -0.5)),
        "w_dnn1": _w((lambda *s: torch.randn(*s, dtype=torch.bfloat16) * 0.8)(Din, Din) * (Din ** -0.5)),
        "b_dnn1": _w((lambda *s: torch.randn(*s, dtype=torch.bfloat16) * 3.2)(Din) * 0.1),
        "w_dnn2": _w((lambda *s: torch.randn(*s, dtype=torch.bfloat16) * 0.2)(Din) * (Din ** -0.5)),
        "b_out": _w((lambda *s: torch.randn(*s, dtype=torch.bfloat16) * 0.2)(1)),
    }

def reference(idx, table, ws_cin, w_cin_out, w_dnn1, b_dnn1, w_dnn2, b_out):
    x0 = table[idx]
    B = x0.shape[0]
    L = ws_cin.shape[0]
    xk = x0
    pooled = []
    for l in range(L):
        xk = torch.einsum('bid,bjd,hij->bhd', xk, x0, ws_cin[l])
        pooled.append(xk.sum(axis=-1))
    p_plus = torch.stack(pooled, axis=1).reshape(B, -1)
    logit_cin = p_plus @ w_cin_out
    h = x0.reshape(B, -1)
    h = _gelu(h @ w_dnn1 + b_dnn1)
    logit_dnn = h @ w_dnn2
    return logit_cin + logit_dnn + b_out
```

```asm
; @launch grid=(256,1,1) block=(512,1,1) lds=159296
.amdgcn_target "amdgcn-amd-amdhsa--gfx950"
.text
.globl standalone__deep_cross_xdeepfm__recsys_kernel
.p2align 8
.type standalone__deep_cross_xdeepfm__recsys_kernel,@function
standalone__deep_cross_xdeepfm__recsys_kernel:
  s_cmp_ge_u32 s2, 256
  s_cbranch_scc1 END
  s_load_dwordx16 s[16:31], s[0:1], 0
  s_load_dwordx4 s[32:35], s[0:1], 64
  s_load_dwordx2 s[100:101], s[0:1], 80
  s_getpc_b64 s[6:7]
  s_lshr_b32 s4, s2, 3
  v_lshl_add_u32 v2, v0, 5, s4
  v_lshlrev_b32 v2, 7, v2
  v_cmp_ge_u32 vcc, 24296, v2
  v_lshrrev_b32 v1, 6, v0
  s_and_saveexec_b64 s[8:9], vcc
  s_cbranch_execz NOPF
  global_load_dword v252, v2, s[6:7]
NOPF:
  s_mov_b64 exec, -1
  v_and_b32 v0, 63, v0
  v_readfirstlane_b32 s3, v1
  v_mov_b32 v3, 0
  v_lshlrev_b32 v10, 2, v0
  v_min_u32 v10, 204, v10
  ds_write_b32 v10, v3 offset:41984
  s_and_b32 s5, s3, 3
  v_and_b32 v1, 15, v0
  v_lshrrev_b32 v2, 4, v0
  s_mov_b32 s39, 0x20000
  s_mov_b32 s43, s39
  s_mov_b32 s47, s39
  s_mov_b32 s15, s39
  v_mov_b32 v31, 262144
  s_lshl_b32 s10, s5, 2
  v_mov_b32 v10, s10
  v_cmp_eq_u32 vcc, 63, v0
  s_mov_b32 s42, 32000
  s_cmp_ge_u32 s3, 4
  v_cndmask_b32 v28, v31, v10, vcc
  s_cbranch_scc1 BH
CIN0:
  s_setprio 3
  s_mov_b32 s82, 0
  s_mov_b32 s14, 0
  s_mov_b32 s71, 0
  s_mov_b32 s72, 0
  s_mul_i32 s81, s4, 3
  s_add_u32 s81, s81, s5
  s_cmp_lt_u32 s4, 9
  s_cselect_b32 s81, s81, 999
  s_and_b32 s6, s2, 7
  s_sub_u32 s6, s6, 1
  s_min_u32 s6, s6, 9
  s_mul_i32 s6, s6, 27
  s_add_u32 s81, s81, s6
  s_mov_b32 s80, 1179648
  s_lshl_b32 s6, s2, 6
  v_add_u32 v19, s6, v0
  v_mul_u32_u24 v19, 104, v19
  s_mov_b32 s38, 35152
  s_mul_i32 s83, s5, 1664
  s_add_u32 s83, s83, 74240
  v_lshrrev_b32 v21, 2, v0
  v_mul_u32_u24 v21, 1352, v21
  v_and_b32 v11, 3, v0
  v_lshl_add_u32 v21, v11, 4, v21
  s_waitcnt lgkmcnt(0)
  s_cmp_lg_u32 s5, 3
  s_cbranch_scc1 A1
  global_load_dwordx4 v[160:163], v19, s[16:17] offset:0
  global_load_dwordx4 v[164:167], v19, s[16:17] offset:16
  global_load_dwordx4 v[168:171], v19, s[16:17] offset:32
  global_load_dwordx4 v[172:175], v19, s[16:17] offset:48
  global_load_dwordx4 v[176:179], v19, s[16:17] offset:64
  global_load_dwordx4 v[180:183], v19, s[16:17] offset:80
  global_load_dwordx2 v[184:185], v19, s[16:17] offset:96
  s_mov_b32 s81, 999
  s_branch ACONT
A1:
  s_cmp_lt_u32 s81, 80
  s_cbranch_scc1 A2
  s_branch PDONE
A2:
  s_mov_b32 s99, s81
  s_cmp_lt_u32 s99, 26
  s_cbranch_scc1 VLOAD
  s_sub_u32 s99, s81, 27
  s_cmp_lt_u32 s99, 26
  s_cbranch_scc1 WLOAD
  s_sub_u32 s99, s81, 54
  s_cmp_lt_u32 s99, 26
  s_cbranch_scc1 TLOAD
  s_branch PDONE
VLOAD:
  s_add_u32 s36, s20, 70304
  s_addc_u32 s37, s21, 0
  s_and_b32 s37, s37, 0xffff
  s_mov_b32 s44, s22
  s_and_b32 s45, s23, 0xffff
  s_mov_b32 s46, 156
  v_lshlrev_b32 v20, 4, v2
  s_mov_b32 m0, s83
  s_mul_i32 s10, s99, 52
  buffer_load_dwordx4 v21, s[36:39], s10 offen lds
  s_add_u32 m0, s83, 1024
  s_add_u32 s10, s10, 21632
  s_mov_b32 exec_hi, 0xff
  buffer_load_dwordx4 v21, s[36:39], s10 offen lds
  s_mov_b32 exec_hi, -1
  buffer_load_dwordx4 v[128:131], v20, s[44:47], 0 offen offset:104
  s_lshl_b32 s10, s99, 1
  buffer_load_ushort v22, v3, s[44:47], s10 offen offset:52
  s_branch V2_
WLOAD:
  s_mov_b32 s36, s20
  s_and_b32 s37, s21, 0xffff
  v_mul_u32_u24 v20, 52, v1
  v_lshl_add_u32 v20, v2, 4, v20
  buffer_load_dwordx4 v[120:123], v20, s[36:39], 0 offen
  s_mul_i32 s11, s99, 1352
  s_mul_i32 s98, s99, 816
  s_add_u32 s98, s98, 74240
  buffer_load_dwordx4 v[112:115], v20, s[36:39], s11 offen
  buffer_load_dwordx4 v[116:119], v20, s[36:39], s11 offen offset:832
  s_branch W2_
TLOAD:
  s_add_u32 s36, s20, 35152
  s_addc_u32 s37, s21, 0
  s_and_b32 s37, s37, 0xffff
  v_lshlrev_b32 v20, 4, v0
  v_lshlrev_b32 v10, 1, v0
  v_min_u32 v11, 26, v10
  buffer_load_dwordx4 v[112:115], v20, s[36:39], 0 offen
  global_load_ushort v22, v10, s[22:23]
  global_load_ushort v23, v11, s[22:23] offset:128
  s_mov_b32 m0, s83
  s_mul_i32 s10, s99, 52
  buffer_load_dwordx4 v21, s[36:39], s10 offen lds
  s_add_u32 m0, s83, 1024
  s_add_u32 s10, s10, 21632
  s_mov_b32 exec_hi, 0xff
  buffer_load_dwordx4 v21, s[36:39], s10 offen lds
  s_mov_b32 exec_hi, -1
  s_branch T1_
BH:
  s_setprio 2
  v_lshlrev_b32 v21, 7, v0
  s_mov_b32 s14, 346112
  s_lshl_b32 s8, s5, 5
  s_add_u32 s8, s8, s4
  s_mul_i32 s8, s8, 22*128
  v_cmp_gt_u32 vcc, 22, v0
  s_lshl_b32 s9, s5, 10
  v_and_b32 v5, 1, v2
  v_xor_b32 v5, v5, v0
  v_lshl_add_u32 v5, v5, 4, s9
  s_lshl_b32 s11, s4, 12
  s_mov_b64 s[84:85], vcc
  s_waitcnt lgkmcnt(0)
  s_mov_b32 s40, s18
  s_and_b32 s41, s19, 0xffff
  s_mov_b32 s12, s24
  s_and_b32 s13, s25, 0xffff
  s_and_b32 s11, s11, 0x7000
  s_add_u32 m0, s9, s11
  s_nop 0
  buffer_load_dwordx4 v5, s[40:43], s11 offen lds
  s_add_u32 s11, s11, 0x1000
  s_and_b32 s11, s11, 0x7000
  s_add_u32 m0, s9, s11
  s_nop 0
  buffer_load_dwordx4 v5, s[40:43], s11 offen lds
  s_add_u32 s11, s11, 0x1000
  s_and_b32 s11, s11, 0x7000
  s_add_u32 m0, s9, s11
  s_nop 0
  buffer_load_dwordx4 v5, s[40:43], s11 offen lds
  s_add_u32 s11, s11, 0x1000
  s_and_b32 s11, s11, 0x7000
  s_add_u32 m0, s9, s11
  s_nop 0
  buffer_load_dwordx4 v5, s[40:43], s11 offen lds
  s_add_u32 s11, s11, 0x1000
  s_and_b32 s11, s11, 0x7000
  s_add_u32 m0, s9, s11
  s_nop 0
  buffer_load_dwordx4 v5, s[40:43], s11 offen lds
  s_add_u32 s11, s11, 0x1000
  s_and_b32 s11, s11, 0x7000
  s_add_u32 m0, s9, s11
  s_nop 0
  buffer_load_dwordx4 v5, s[40:43], s11 offen lds
  s_add_u32 s11, s11, 0x1000
  s_and_b32 s11, s11, 0x7000
  s_add_u32 m0, s9, s11
  s_nop 0
  buffer_load_dwordx4 v5, s[40:43], s11 offen lds
  s_add_u32 s11, s11, 0x1000
  s_and_b32 s11, s11, 0x7000
  s_add_u32 m0, s9, s11
  s_nop 0
  buffer_load_dwordx4 v5, s[40:43], s11 offen lds
  s_add_u32 s11, s11, 0x1000
  v_lshlrev_b32 v21, 14, v0
  s_lshl_b32 s8, s4, 2
  s_add_u32 s8, s8, s5
  s_lshl_b32 s8, s8, 7
  s_mov_b64 exec, 15
  buffer_load_dword v252, v21, s[12:15], s8 offen
  s_mov_b64 exec, -1
  v_add_u32 v8, 0, v0
  v_mul_u32_u24 v9, 0x1556, v8
  v_lshrrev_b32 v9, 16, v9
  v_mul_u32_u24 v9, 640, v9
  v_lshl_add_u32 v32, v8, 4, v9
  v_add_u32 v8, 64, v0
  v_mul_u32_u24 v9, 0x1556, v8
  v_lshrrev_b32 v9, 16, v9
  v_mul_u32_u24 v9, 640, v9
  v_lshl_add_u32 v33, v8, 4, v9
  v_add_u32 v8, 128, v0
  v_mul_u32_u24 v9, 0x1556, v8
  v_lshrrev_b32 v9, 16, v9
  v_mul_u32_u24 v9, 640, v9
  v_lshl_add_u32 v34, v8, 4, v9
  v_lshrrev_b32 v8, 2, v0
  v_mul_u32_u24 v8, 768, v8
  v_lshl_add_u32 v35, v0, 4, v8
  s_mul_i32 s87, s5, 192
  s_sub_u32 s6, 768, s87
  v_add_u32 v35, s6, v35
  s_mul_i32 s95, s5, 10240
  s_add_u32 s95, s95, 118336
  s_add_u32 s6, s5, 0
  s_and_b32 s6, s6, 3
  s_mul_i32 s72, s6, 13312
  s_add_u32 s72, s72, s87
  s_lshl_b32 s80, s6, 4
  s_add_u32 s6, s5, 1
  s_and_b32 s6, s6, 3
  s_mul_i32 s73, s6, 13312
  s_add_u32 s73, s73, s87
  s_lshl_b32 s81, s6, 4
  s_add_u32 s6, s5, 2
  s_and_b32 s6, s6, 3
  s_mul_i32 s74, s6, 13312
  s_add_u32 s74, s74, s87
  s_lshl_b32 s82, s6, 4
  s_add_u32 s6, s5, 3
  s_and_b32 s6, s6, 3
  s_mul_i32 s75, s6, 13312
  s_add_u32 s75, s75, s87
  s_lshl_b32 s83, s6, 4
DNN:
  s_add_u32 m0, s95, 9216
  s_add_u32 s98, s72, 0
  buffer_load_dwordx4 v35, s[12:15], s98 offen lds
  s_add_u32 m0, s95, 0
  s_nop 0
  buffer_load_dwordx4 v32, s[12:15], s98 offen lds
  s_add_u32 m0, s95, 1024
  s_nop 0
  buffer_load_dwordx4 v33, s[12:15], s98 offen lds
  s_add_u32 m0, s95, 2048
  s_nop 0
  buffer_load_dwordx4 v34, s[12:15], s98 offen lds
  s_add_u32 s6, s5, 0
  s_and_b32 s6, s6, 1
  s_add_u32 s6, s6, 24
  s_mul_i32 s76, s6, 13312
  s_add_u32 s76, s76, s87
  s_add_u32 s6, s5, 1
  s_and_b32 s6, s6, 1
  s_add_u32 s6, s6, 24
  s_mul_i32 s77, s6, 13312
  s_add_u32 s77, s77, s87
  s_mul_i32 s6, s5, 96
  v_add_u32 v8, s6, v0
  v_add_u32 v9, 64, v8
  v_add_u32 v10, 352, v0
  v_cmp_gt_u32 vcc, 32, v0
  v_lshlrev_b32 v22, 1, v8
  v_lshrrev_b32 v1, 5, v0
  v_cndmask_b32 v9, v10, v9, vcc
  v_lshlrev_b32 v23, 1, v9
  v_bfe_u32 v2, v0, 2, 2
  v_lshl_add_u32 v2, v1, 3, v2
  v_bfe_u32 v4, v0, 4, 1
  v_and_b32 v10, 3, v0
  v_lshlrev_b32 v10, 3, v10
  v_lshl_add_u32 v10, v4, 5, v10
  v_mul_u32_u24 v6, 192, v2
  v_add3_u32 v6, v6, v10, s95
  v_lshl_add_u32 v7, v2, 6, v10
  v_add_u32 v7, s95, v7
  v_and_b32 v2, 31, v0
  v_mul_u32_u24 v2, 144, v2
  v_lshlrev_b32 v4, 4, v1
  v_add_u32 v8, s80, v2
  v_add_u32 v9, s81, v2
  v_add_u32 v10, s82, v2
  v_add_u32 v11, s83, v2
  s_waitcnt vmcnt(5)
  s_barrier
  ds_read_b128 v[36:39], v8 offset:32768
  ds_read_b128 v[40:43], v8 offset:37376
  ds_read_b128 v[44:47], v9 offset:32768
  ds_read_b128 v[48:51], v9 offset:37376
  ds_read_b128 v[52:55], v10 offset:32768
  ds_read_b128 v[56:59], v10 offset:37376
  ds_read_b128 v[112:115], v11 offset:32768
  ds_read_b128 v[116:119], v11 offset:37376
  ds_write_b32 v28, v0 offset:42080
  s_add_u32 m0, s95, 3072
  s_add_u32 s98, s73, 0
  buffer_load_dwordx4 v32, s[12:15], s98 offen lds
  s_add_u32 m0, s95, 4096
  s_nop 0
  buffer_load_dwordx4 v33, s[12:15], s98 offen lds
  s_add_u32 m0, s95, 5120
  s_nop 0
  buffer_load_dwordx4 v34, s[12:15], s98 offen lds
  s_add_u32 m0, s95, 6144
  s_add_u32 s98, s74, 0
  buffer_load_dwordx4 v32, s[12:15], s98 offen lds
  s_add_u32 m0, s95, 7168
  s_nop 0
  buffer_load_dwordx4 v33, s[12:15], s98 offen lds
  s_add_u32 m0, s95, 8192
  s_nop 0
  buffer_load_dwordx4 v34, s[12:15], s98 offen lds
  global_load_ushort v24, v22, s[26:27]
  global_load_ushort v25, v23, s[26:27]
  global_load_ushort v26, v22, s[28:29]
  global_load_ushort v27, v23, s[28:29]
  s_mov_b64 exec, 4194288
  buffer_load_dword v20, v21, s[12:15], s8 offen
  s_mov_b64 exec, -1
  s_setprio 2
  s_waitcnt lgkmcnt(7)
  v_xor_b32_sdwa v60, v4, v36 dst_sel:DWORD dst_unused:UNUSED_PAD src0_sel:DWORD src1_sel:WORD_0
  ds_read_b128 v[96:99], v60 offset:0
  v_xor_b32_sdwa v61, v4, v40 dst_sel:DWORD dst_unused:UNUSED_PAD src0_sel:DWORD src1_sel:WORD_0
  ds_read_b128 v[100:103], v61 offset:0
  s_waitcnt vmcnt(11)
  ds_read_b64_tr_b16 v[64:65], v6 offset:0
  ds_read_b64_tr_b16 v[66:67], v6 offset:768
  ds_read_b64_tr_b16 v[68:69], v6 offset:64
  ds_read_b64_tr_b16 v[70:71], v6 offset:832
  ds_read_b64_tr_b16 v[72:73], v6 offset:128
  ds_read_b64_tr_b16 v[74:75], v6 offset:896
  ds_read_b64_tr_b16 v[76:77], v7 offset:9216
  ds_read_b64_tr_b16 v[78:79], v7 offset:9472
  s_waitcnt lgkmcnt(0)
  v_mfma_f32_32x32x16_bf16 v[128:143], v[64:67], v[96:99], 0
  v_xor_b32_sdwa v60, v4, v44 dst_sel:DWORD dst_unused:UNUSED_PAD src0_sel:DWORD src1_sel:WORD_0
  ds_read_b128 v[104:107], v60 offset:0
  v_xor_b32_sdwa v61, v4, v48 dst_sel:DWORD dst_unused:UNUSED_PAD src0_sel:DWORD src1_sel:WORD_0
  ds_read_b128 v[108:111], v61 offset:0
  s_add_u32 m0, s95, 0
  s_add_u32 s98, s75, 0
  buffer_load_dwordx4 v32, s[12:15], s98 offen lds
  v_mfma_f32_32x32x16_bf16 v[144:159], v[64:67], v[100:103], 0
  s_add_u32 m0, s95, 1024
  s_nop 0
  buffer_load_dwordx4 v33, s[12:15], s98 offen lds
  s_add_u32 m0, s95, 2048
  s_nop 0
  buffer_load_dwordx4 v34, s[12:15], s98 offen lds
  v_mfma_f32_32x32x16_bf16 v[160:175], v[68:71], v[96:99], 0
  v_mfma_f32_32x32x16_bf16 v[176:191], v[68:71], v[100:103], 0
  v_mfma_f32_32x32x16_bf16 v[192:207], v[72:75], v[96:99], 0
  s_waitcnt vmcnt(11)
  ds_read_b64_tr_b16 v[80:81], v6 offset:3072
  ds_read_b64_tr_b16 v[82:83], v6 offset:3840
  ds_read_b64_tr_b16 v[84:85], v6 offset:3136
  ds_read_b64_tr_b16 v[86:87], v6 offset:3904
  ds_read_b64_tr_b16 v[88:89], v6 offset:3200
  ds_read_b64_tr_b16 v[90:91], v6 offset:3968
  v_mfma_f32_32x32x16_bf16 v[208:223], v[72:75], v[100:103], 0
  s_waitcnt lgkmcnt(0)
  s_add_u32 m0, s95, 9216
  s_add_u32 s98, s72, 53248
  buffer_load_dwordx4 v35, s[12:15], s98 offen lds
  s_add_u32 m0, s95, 3072
  s_nop 0
  buffer_load_dwordx4 v32, s[12:15], s98 offen lds
  v_mfma_f32_32x32x16_bf16 v[224:239], v[76:79], v[96:99], 0
  s_add_u32 m0, s95, 4096
  s_nop 0
  buffer_load_dwordx4 v33, s[12:15], s98 offen lds
  v_mfma_f32_32x32x16_bf16 v[240:255], v[76:79], v[100:103], 0
  s_add_u32 m0, s95, 5120
  s_nop 0
  buffer_load_dwordx4 v34, s[12:15], s98 offen lds
  s_waitcnt vmcnt(12) lgkmcnt(0)
  v_mfma_f32_32x32x16_bf16 v[128:143], v[80:83], v[104:107], v[128:143]
  ds_read_b64_tr_b16 v[64:65], v6 offset:6144
  ds_read_b64_tr_b16 v[66:67], v6 offset:6912
  ds_read_b64_tr_b16 v[68:69], v6 offset:6208
  v_mfma_f32_32x32x16_bf16 v[144:159], v[80:83], v[108:111], v[144:159]
  ds_read_b64_tr_b16 v[70:71], v6 offset:6976
  ds_read_b64_tr_b16 v[72:73], v6 offset:6272
  ds_read_b64_tr_b16 v[74:75], v6 offset:7040
  v_mfma_f32_32x32x16_bf16 v[160:175], v[84:87], v[104:107], v[160:175]
  v_xor_b32_sdwa v60, v4, v52 dst_sel:DWORD dst_unused:UNUSED_PAD src0_sel:DWORD src1_sel:WORD_0
  ds_read_b128 v[96:99], v60 offset:0
  v_xor_b32_sdwa v61, v4, v56 dst_sel:DWORD dst_unused:UNUSED_PAD src0_sel:DWORD src1_sel:WORD_0
  ds_read_b128 v[100:103], v61 offset:0
  v_mfma_f32_32x32x16_bf16 v[176:191], v[84:87], v[108:111], v[176:191]
  s_waitcnt lgkmcnt(2)
  s_add_u32 m0, s95, 6144
  s_add_u32 s98, s73, 53248
  buffer_load_dwordx4 v32, s[12:15], s98 offen lds
  v_mfma_f32_32x32x16_bf16 v[192:207], v[88:91], v[104:107], v[192:207]
  s_add_u32 m0, s95, 7168
  s_nop 0
  buffer_load_dwordx4 v33, s[12:15], s98 offen lds
  v_mfma_f32_32x32x16_bf16 v[208:223], v[88:91], v[108:111], v[208:223]
  s_add_u32 m0, s95, 8192
  s_nop 0
  buffer_load_dwordx4 v34, s[12:15], s98 offen lds
  s_waitcnt vmcnt(7) lgkmcnt(0)
  v_mfma_f32_32x32x16_bf16 v[128:143], v[64:67], v[96:99], v[128:143]
  ds_read_b64_tr_b16 v[80:81], v6 offset:0
  ds_read_b64_tr_b16 v[82:83], v6 offset:768
  ds_read_b64_tr_b16 v[84:85], v6 offset:64
  v_mfma_f32_32x32x16_bf16 v[144:159], v[64:67], v[100:103], v[144:159]
  ds_read_b64_tr_b16 v[86:87], v6 offset:832
  ds_read_b64_tr_b16 v[88:89], v6 offset:128
  ds_read_b64_tr_b16 v[90:91], v6 offset:896
  v_mfma_f32_32x32x16_bf16 v[160:175], v[68:71], v[96:99], v[160:175]
  v_xor_b32_sdwa v60, v4, v112 dst_sel:DWORD dst_unused:UNUSED_PAD src0_sel:DWORD src1_sel:WORD_0
  ds_read_b128 v[104:107], v60 offset:0
  v_xor_b32_sdwa v61, v4, v116 dst_sel:DWORD dst_unused:UNUSED_PAD src0_sel:DWORD src1_sel:WORD_0
  ds_read_b128 v[108:111], v61 offset:0
  v_mfma_f32_32x32x16_bf16 v[176:191], v[68:71], v[100:103], v[176:191]
  s_waitcnt lgkmcnt(2)
  s_add_u32 m0, s95, 0
  s_add_u32 s98, s74, 53248
  buffer_load_dwordx4 v32, s[12:15], s98 offen lds
  v_mfma_f32_32x32x16_bf16 v[192:207], v[72:75], v[96:99], v[192:207]
  s_add_u32 m0, s95, 1024
  s_nop 0
  buffer_load_dwordx4 v33, s[12:15], s98 offen lds
  v_mfma_f32_32x32x16_bf16 v[208:223], v[72:75], v[100:103], v[208:223]
  s_add_u32 m0, s95, 2048
  s_nop 0
  buffer_load_dwordx4 v34, s[12:15], s98 offen lds
  s_waitcnt vmcnt(6) lgkmcnt(0)
  v_mfma_f32_32x32x16_bf16 v[128:143], v[80:83], v[104:107], v[128:143]
  ds_read_b64_tr_b16 v[64:65], v6 offset:3072
  ds_read_b64_tr_b16 v[66:67], v6 offset:3840
  ds_read_b64_tr_b16 v[68:69], v6 offset:3136
  ds_read_b64_tr_b16 v[70:71], v6 offset:3904
  v_mfma_f32_32x32x16_bf16 v[144:159], v[80:83], v[108:111], v[144:159]
  ds_read_b64_tr_b16 v[72:73], v6 offset:3200
  ds_read_b64_tr_b16 v[74:75], v6 offset:3968
  ds_read_b64_tr_b16 v[76:77], v7 offset:9216
  ds_read_b64_tr_b16 v[78:79], v7 offset:9472
  v_mfma_f32_32x32x16_bf16 v[160:175], v[84:87], v[104:107], v[160:175]
  v_xor_b32_sdwa v60, v4, v36 dst_sel:DWORD dst_unused:UNUSED_PAD src0_sel:DWORD src1_sel:WORD_1
  ds_read_b128 v[96:99], v60 offset:0
  v_xor_b32_sdwa v61, v4, v40 dst_sel:DWORD dst_unused:UNUSED_PAD src0_sel:DWORD src1_sel:WORD_1
  ds_read_b128 v[100:103], v61 offset:0
  v_mfma_f32_32x32x16_bf16 v[176:191], v[84:87], v[108:111], v[176:191]
  s_waitcnt lgkmcnt(2)
  s_add_u32 m0, s95, 3072
  s_add_u32 s98, s75, 53248
  buffer_load_dwordx4 v32, s[12:15], s98 offen lds
  v_mfma_f32_32x32x16_bf16 v[192:207], v[88:91], v[104:107], v[192:207]
  s_add_u32 m0, s95, 4096
  s_nop 0
  buffer_load_dwordx4 v33, s[12:15], s98 offen lds
  v_mfma_f32_32x32x16_bf16 v[208:223], v[88:91], v[108:111], v[208:223]
  s_add_u32 m0, s95, 5120
  s_nop 0
  buffer_load_dwordx4 v34, s[12:15], s98 offen lds
  s_waitcnt vmcnt(6) lgkmcnt(0)
  v_mfma_f32_32x32x16_bf16 v[128:143], v[64:67], v[96:99], v[128:143]
  ds_read_b64_tr_b16 v[80:81], v6 offset:6144
  ds_read_b64_tr_b16 v[82:83], v6 offset:6912
  ds_read_b64_tr_b16 v[84:85], v6 offset:6208
  v_mfma_f32_32x32x16_bf16 v[144:159], v[64:67], v[100:103], v[144:159]
  ds_read_b64_tr_b16 v[86:87], v6 offset:6976
  ds_read_b64_tr_b16 v[88:89], v6 offset:6272
  ds_read_b64_tr_b16 v[90:91], v6 offset:7040
  v_mfma_f32_32x32x16_bf16 v[160:175], v[68:71], v[96:99], v[160:175]
  v_xor_b32_sdwa v60, v4, v44 dst_sel:DWORD dst_unused:UNUSED_PAD src0_sel:DWORD src1_sel:WORD_1
  ds_read_b128 v[104:107], v60 offset:0
  v_xor_b32_sdwa v61, v4, v48 dst_sel:DWORD dst_unused:UNUSED_PAD src0_sel:DWORD src1_sel:WORD_1
  ds_read_b128 v[108:111], v61 offset:0
  v_mfma_f32_32x32x16_bf16 v[176:191], v[68:71], v[100:103], v[176:191]
  v_mfma_f32_32x32x16_bf16 v[192:207], v[72:75], v[96:99], v[192:207]
  v_mfma_f32_32x32x16_bf16 v[208:223], v[72:75], v[100:103], v[208:223]
  s_waitcnt lgkmcnt(2)
  s_add_u32 m0, s95, 9216
  s_add_u32 s98, s72, 106496
  buffer_load_dwordx4 v35, s[12:15], s98 offen lds
  s_add_u32 m0, s95, 6144
  s_nop 0
  buffer_load_dwordx4 v32, s[12:15], s98 offen lds
  v_mfma_f32_32x32x16_bf16 v[224:239], v[76:79], v[96:99], v[224:239]
  s_add_u32 m0, s95, 7168
  s_nop 0
  buffer_load_dwordx4 v33, s[12:15], s98 offen lds
  v_mfma_f32_32x32x16_bf16 v[240:255], v[76:79], v[100:103], v[240:255]
  s_add_u32 m0, s95, 8192
  s_nop 0
  buffer_load_dwordx4 v34, s[12:15], s98 offen lds
  s_waitcnt vmcnt(7) lgkmcnt(0)
  v_mfma_f32_32x32x16_bf16 v[128:143], v[80:83], v[104:107], v[128:143]
  ds_read_b64_tr_b16 v[64:65], v6 offset:0
  ds_read_b64_tr_b16 v[66:67], v6 offset:768
  ds_read_b64_tr_b16 v[68:69], v6 offset:64
  v_mfma_f32_32x32x16_bf16 v[144:159], v[80:83], v[108:111], v[144:159]
  ds_read_b64_tr_b16 v[70:71], v6 offset:832
  ds_read_b64_tr_b16 v[72:73], v6 offset:128
  ds_read_b64_tr_b16 v[74:75], v6 offset:896
  v_mfma_f32_32x32x16_bf16 v[160:175], v[84:87], v[104:107], v[160:175]
  v_xor_b32_sdwa v60, v4, v52 dst_sel:DWORD dst_unused:UNUSED_PAD src0_sel:DWORD src1_sel:WORD_1
  ds_read_b128 v[96:99], v60 offset:0
  v_xor_b32_sdwa v61, v4, v56 dst_sel:DWORD dst_unused:UNUSED_PAD src0_sel:DWORD src1_sel:WORD_1
  ds_read_b128 v[100:103], v61 offset:0
  v_mfma_f32_32x32x16_bf16 v[176:191], v[84:87], v[108:111], v[176:191]
  s_waitcnt lgkmcnt(2)
  s_add_u32 m0, s95, 0
  s_add_u32 s98, s73, 106496
  buffer_load_dwordx4 v32, s[12:15], s98 offen lds
  v_mfma_f32_32x32x16_bf16 v[192:207], v[88:91], v[104:107], v[192:207]
  s_add_u32 m0, s95, 1024
  s_nop 0
  buffer_load_dwordx4 v33, s[12:15], s98 offen lds
  v_mfma_f32_32x32x16_bf16 v[208:223], v[88:91], v[108:111], v[208:223]
  s_add_u32 m0, s95, 2048
  s_nop 0
  buffer_load_dwordx4 v34, s[12:15], s98 offen lds
  s_waitcnt vmcnt(7) lgkmcnt(0)
  v_mfma_f32_32x32x16_bf16 v[128:143], v[64:67], v[96:99], v[128:143]
  ds_read_b64_tr_b16 v[80:81], v6 offset:3072
  ds_read_b64_tr_b16 v[82:83], v6 offset:3840
  ds_read_b64_tr_b16 v[84:85], v6 offset:3136
  v_mfma_f32_32x32x16_bf16 v[144:159], v[64:67], v[100:103], v[144:159]
  ds_read_b64_tr_b16 v[86:87], v6 offset:3904
  ds_read_b64_tr_b16 v[88:89], v6 offset:3200
  ds_read_b64_tr_b16 v[90:91], v6 offset:3968
  v_mfma_f32_32x32x16_bf16 v[160:175], v[68:71], v[96:99], v[160:175]
  v_xor_b32_sdwa v60, v4, v112 dst_sel:DWORD dst_unused:UNUSED_PAD src0_sel:DWORD src1_sel:WORD_1
  ds_read_b128 v[104:107], v60 offset:0
  v_xor_b32_sdwa v61, v4, v116 dst_sel:DWORD dst_unused:UNUSED_PAD src0_sel:DWORD src1_sel:WORD_1
  ds_read_b128 v[108:111], v61 offset:0
  v_mfma_f32_32x32x16_bf16 v[176:191], v[68:71], v[100:103], v[176:191]
  s_waitcnt lgkmcnt(2)
  s_add_u32 m0, s95, 3072
  s_add_u32 s98, s74, 106496
  buffer_load_dwordx4 v32, s[12:15], s98 offen lds
  v_mfma_f32_32x32x16_bf16 v[192:207], v[72:75], v[96:99], v[192:207]
  s_add_u32 m0, s95, 4096
  s_nop 0
  buffer_load_dwordx4 v33, s[12:15], s98 offen lds
  v_mfma_f32_32x32x16_bf16 v[208:223], v[72:75], v[100:103], v[208:223]
  s_add_u32 m0, s95, 5120
  s_nop 0
  buffer_load_dwordx4 v34, s[12:15], s98 offen lds
  s_waitcnt vmcnt(6) lgkmcnt(0)
  v_mfma_f32_32x32x16_bf16 v[128:143], v[80:83], v[104:107], v[128:143]
  ds_read_b64_tr_b16 v[64:65], v6 offset:6144
  ds_read_b64_tr_b16 v[66:67], v6 offset:6912
  ds_read_b64_tr_b16 v[68:69], v6 offset:6208
  ds_read_b64_tr_b16 v[70:71], v6 offset:6976
  v_mfma_f32_32x32x16_bf16 v[144:159], v[80:83], v[108:111], v[144:159]
  ds_read_b64_tr_b16 v[72:73], v6 offset:6272
  ds_read_b64_tr_b16 v[74:75], v6 offset:7040
  ds_read_b64_tr_b16 v[76:77], v7 offset:9216
  ds_read_b64_tr_b16 v[78:79], v7 offset:9472
  v_mfma_f32_32x32x16_bf16 v[160:175], v[84:87], v[104:107], v[160:175]
  v_xor_b32_sdwa v60, v4, v37 dst_sel:DWORD dst_unused:UNUSED_PAD src0_sel:DWORD src1_sel:WORD_0
  ds_read_b128 v[96:99], v60 offset:0
  v_xor_b32_sdwa v61, v4, v41 dst_sel:DWORD dst_unused:UNUSED_PAD src0_sel:DWORD src1_sel:WORD_0
  ds_read_b128 v[100:103], v61 offset:0
  v_mfma_f32_32x32x16_bf16 v[176:191], v[84:87], v[108:111], v[176:191]
  s_waitcnt lgkmcnt(2)
  s_add_u32 m0, s95, 6144
  s_add_u32 s98, s75, 106496
  buffer_load_dwordx4 v32, s[12:15], s98 offen lds
  v_mfma_f32_32x32x16_bf16 v[192:207], v[88:91], v[104:107], v[192:207]
  s_add_u32 m0, s95, 7168
  s_nop 0
  buffer_load_dwordx4 v33, s[12:15], s98 offen lds
  v_mfma_f32_32x32x16_bf16 v[208:223], v[88:91], v[108:111], v[208:223]
  s_add_u32 m0, s95, 8192
  s_nop 0
  buffer_load_dwordx4 v34, s[12:15], s98 offen lds
  s_waitcnt vmcnt(6) lgkmcnt(0)
  v_mfma_f32_32x32x16_bf16 v[128:143], v[64:67], v[96:99], v[128:143]
  ds_read_b64_tr_b16 v[80:81], v6 offset:0
  ds_read_b64_tr_b16 v[82:83], v6 offset:768
  ds_read_b64_tr_b16 v[84:85], v6 offset:64
  v_mfma_f32_32x32x16_bf16 v[144:159], v[64:67], v[100:103], v[144:159]
  ds_read_b64_tr_b16 v[86:87], v6 offset:832
  ds_read_b64_tr_b16 v[88:89], v6 offset:128
  ds_read_b64_tr_b16 v[90:91], v6 offset:896
  v_mfma_f32_32x32x16_bf16 v[160:175], v[68:71], v[96:99], v[160:175]
  v_xor_b32_sdwa v60, v4, v45 dst_sel:DWORD dst_unused:UNUSED_PAD src0_sel:DWORD src1_sel:WORD_0
  ds_read_b128 v[104:107], v60 offset:0
  v_xor_b32_sdwa v61, v4, v49 dst_sel:DWORD dst_unused:UNUSED_PAD src0_sel:DWORD src1_sel:WORD_0
  ds_read_b128 v[108:111], v61 offset:0
  v_mfma_f32_32x32x16_bf16 v[176:191], v[68:71], v[100:103], v[176:191]
  v_mfma_f32_32x32x16_bf16 v[192:207], v[72:75], v[96:99], v[192:207]
  v_mfma_f32_32x32x16_bf16 v[208:223], v[72:75], v[100:103], v[208:223]
  s_waitcnt lgkmcnt(2)
  s_add_u32 m0, s95, 9216
  s_add_u32 s98, s72, 159744
  buffer_load_dwordx4 v35, s[12:15], s98 offen lds
  s_add_u32 m0, s95, 0
  s_nop 0
  buffer_load_dwordx4 v32, s[12:15], s98 offen lds
  v_mfma_f32_32x32x16_bf16 v[224:239], v[76:79], v[96:99], v[224:239]
  s_add_u32 m0, s95, 1024
  s_nop 0
  buffer_load_dwordx4 v33, s[12:15], s98 offen lds
  v_mfma_f32_32x32x16_bf16 v[240:255], v[76:79], v[100:103], v[240:255]
  s_add_u32 m0, s95, 2048
  s_nop 0
  buffer_load_dwordx4 v34, s[12:15], s98 offen lds
  s_waitcnt vmcnt(7) lgkmcnt(0)
  v_mfma_f32_32x32x16_bf16 v[128:143], v[80:83], v[104:107], v[128:143]
  ds_read_b64_tr_b16 v[64:65], v6 offset:3072
  ds_read_b64_tr_b16 v[66:67], v6 offset:3840
  ds_read_b64_tr_b16 v[68:69], v6 offset:3136
  v_mfma_f32_32x32x16_bf16 v[144:159], v[80:83], v[108:111], v[144:159]
  ds_read_b64_tr_b16 v[70:71], v6 offset:3904
  ds_read_b64_tr_b16 v[72:73], v6 offset:3200
  ds_read_b64_tr_b16 v[74:75], v6 offset:3968
  v_mfma_f32_32x32x16_bf16 v[160:175], v[84:87], v[104:107], v[160:175]
  v_xor_b32_sdwa v60, v4, v53 dst_sel:DWORD dst_unused:UNUSED_PAD src0_sel:DWORD src1_sel:WORD_0
  ds_read_b128 v[96:99], v60 offset:0
  v_xor_b32_sdwa v61, v4, v57 dst_sel:DWORD dst_unused:UNUSED_PAD src0_sel:DWORD src1_sel:WORD_0
  ds_read_b128 v[100:103], v61 offset:0
  v_mfma_f32_32x32x16_bf16 v[176:191], v[84:87], v[108:111], v[176:191]
  s_waitcnt lgkmcnt(2)
  s_add_u32 m0, s95, 3072
  s_add_u32 s98, s73, 159744
  buffer_load_dwordx4 v32, s[12:15], s98 offen lds
  v_mfma_f32_32x32x16_bf16 v[192:207], v[88:91], v[104:107], v[192:207]
  s_add_u32 m0, s95, 4096
  s_nop 0
  buffer_load_dwordx4 v33, s[12:15], s98 offen lds
  v_mfma_f32_32x32x16_bf16 v[208:223], v[88:91], v[108:111], v[208:223]
  s_add_u32 m0, s95, 5120
  s_nop 0
  buffer_load_dwordx4 v34, s[12:15], s98 offen lds
  s_waitcnt vmcnt(7) lgkmcnt(0)
  v_mfma_f32_32x32x16_bf16 v[128:143], v[64:67], v[96:99], v[128:143]
  ds_read_b64_tr_b16 v[80:81], v6 offset:6144
  ds_read_b64_tr_b16 v[82:83], v6 offset:6912
  ds_read_b64_tr_b16 v[84:85], v6 offset:6208
  v_mfma_f32_32x32x16_bf16 v[144:159], v[64:67], v[100:103], v[144:159]
  ds_read_b64_tr_b16 v[86:87], v6 offset:6976
  ds_read_b64_tr_b16 v[88:89], v6 offset:6272
  ds_read_b64_tr_b16 v[90:91], v6 offset:7040
  v_mfma_f32_32x32x16_bf16 v[160:175], v[68:71], v[96:99], v[160:175]
  v_xor_b32_sdwa v60, v4, v113 dst_sel:DWORD dst_unused:UNUSED_PAD src0_sel:DWORD src1_sel:WORD_0
  ds_read_b128 v[104:107], v60 offset:0
  v_xor_b32_sdwa v61, v4, v117 dst_sel:DWORD dst_unused:UNUSED_PAD src0_sel:DWORD src1_sel:WORD_0
  ds_read_b128 v[108:111], v61 offset:0
  v_mfma_f32_32x32x16_bf16 v[176:191], v[68:71], v[100:103], v[176:191]
  s_waitcnt lgkmcnt(2)
  s_add_u32 m0, s95, 6144
  s_add_u32 s98, s74, 159744
  buffer_load_dwordx4 v32, s[12:15], s98 offen lds
  v_mfma_f32_32x32x16_bf16 v[192:207], v[72:75], v[96:99], v[192:207]
  s_add_u32 m0, s95, 7168
  s_nop 0
  buffer_load_dwordx4 v33, s[12:15], s98 offen lds
  v_mfma_f32_32x32x16_bf16 v[208:223], v[72:75], v[100:103], v[208:223]
  s_add_u32 m0, s95, 8192
  s_nop 0
  buffer_load_dwordx4 v34, s[12:15], s98 offen lds
  s_waitcnt vmcnt(6) lgkmcnt(0)
  v_mfma_f32_32x32x16_bf16 v[128:143], v[80:83], v[104:107], v[128:143]
  ds_read_b64_tr_b16 v[64:65], v6 offset:0
  ds_read_b64_tr_b16 v[66:67], v6 offset:768
  ds_read_b64_tr_b16 v[68:69], v6 offset:64
  ds_read_b64_tr_b16 v[70:71], v6 offset:832
  v_mfma_f32_32x32x16_bf16 v[144:159], v[80:83], v[108:111], v[144:159]
  ds_read_b64_tr_b16 v[72:73], v6 offset:128
  ds_read_b64_tr_b16 v[74:75], v6 offset:896
  ds_read_b64_tr_b16 v[76:77], v7 offset:9216
  ds_read_b64_tr_b16 v[78:79], v7 offset:9472
  v_mfma_f32_32x32x16_bf16 v[160:175], v[84:87], v[104:107], v[160:175]
  v_xor_b32_sdwa v60, v4, v37 dst_sel:DWORD dst_unused:UNUSED_PAD src0_sel:DWORD src1_sel:WORD_1
  ds_read_b128 v[96:99], v60 offset:0
  v_xor_b32_sdwa v61, v4, v41 dst_sel:DWORD dst_unused:UNUSED_PAD src0_sel:DWORD src1_sel:WORD_1
  ds_read_b128 v[100:103], v61 offset:0
  v_mfma_f32_32x32x16_bf16 v[176:191], v[84:87], v[108:111], v[176:191]
  s_waitcnt lgkmcnt(2)
  s_add_u32 m0, s95, 0
  s_add_u32 s98, s75, 159744
  buffer_load_dwordx4 v32, s[12:15], s98 offen lds
  v_mfma_f32_32x32x16_bf16 v[192:207], v[88:91], v[104:107], v[192:207]
  s_add_u32 m0, s95, 1024
  s_nop 0
  buffer_load_dwordx4 v33, s[12:15], s98 offen lds
  v_mfma_f32_32x32x16_bf16 v[208:223], v[88:91], v[108:111], v[208:223]
  s_add_u32 m0, s95, 2048
  s_nop 0
  buffer_load_dwordx4 v34, s[12:15], s98 offen lds
  s_waitcnt vmcnt(6) lgkmcnt(0)
  v_mfma_f32_32x32x16_bf16 v[128:143], v[64:67], v[96:99], v[128:143]
  ds_read_b64_tr_b16 v[80:81], v6 offset:3072
  ds_read_b64_tr_b16 v[82:83], v6 offset:3840
  ds_read_b64_tr_b16 v[84:85], v6 offset:3136
  v_mfma_f32_32x32x16_bf16 v[144:159], v[64:67], v[100:103], v[144:159]
  ds_read_b64_tr_b16 v[86:87], v6 offset:3904
  ds_read_b64_tr_b16 v[88:89], v6 offset:3200
  ds_read_b64_tr_b16 v[90:91], v6 offset:3968
  v_mfma_f32_32x32x16_bf16 v[160:175], v[68:71], v[96:99], v[160:175]
  v_xor_b32_sdwa v60, v4, v45 dst_sel:DWORD dst_unused:UNUSED_PAD src0_sel:DWORD src1_sel:WORD_1
  ds_read_b128 v[104:107], v60 offset:0
  v_xor_b32_sdwa v61, v4, v49 dst_sel:DWORD dst_unused:UNUSED_PAD src0_sel:DWORD src1_sel:WORD_1
  ds_read_b128 v[108:111], v61 offset:0
  v_mfma_f32_32x32x16_bf16 v[176:191], v[68:71], v[100:103], v[176:191]
  v_mfma_f32_32x32x16_bf16 v[192:207], v[72:75], v[96:99], v[192:207]
  v_mfma_f32_32x32x16_bf16 v[208:223], v[72:75], v[100:103], v[208:223]
  s_waitcnt lgkmcnt(2)
  s_add_u32 m0, s95, 9216
  s_add_u32 s98, s72, 212992
  buffer_load_dwordx4 v35, s[12:15], s98 offen lds
  s_add_u32 m0, s95, 3072
  s_nop 0
  buffer_load_dwordx4 v32, s[12:15], s98 offen lds
  v_mfma_f32_32x32x16_bf16 v[224:239], v[76:79], v[96:99], v[224:239]
  s_add_u32 m0, s95, 4096
  s_nop 0
  buffer_load_dwordx4 v33, s[12:15], s98 offen lds
  v_mfma_f32_32x32x16_bf16 v[240:255], v[76:79], v[100:103], v[240:255]
  s_add_u32 m0, s95, 5120
  s_nop 0
  buffer_load_dwordx4 v34, s[12:15], s98 offen lds
  s_waitcnt vmcnt(7) lgkmcnt(0)
  v_mfma_f32_32x32x16_bf16 v[128:143], v[80:83], v[104:107], v[128:143]
  ds_read_b64_tr_b16 v[64:65], v6 offset:6144
  ds_read_b64_tr_b16 v[66:67], v6 offset:6912
  ds_read_b64_tr_b16 v[68:69], v6 offset:6208
  v_mfma_f32_32x32x16_bf16 v[144:159], v[80:83], v[108:111], v[144:159]
  ds_read_b64_tr_b16 v[70:71], v6 offset:6976
  ds_read_b64_tr_b16 v[72:73], v6 offset:6272
  ds_read_b64_tr_b16 v[74:75], v6 offset:7040
  v_mfma_f32_32x32x16_bf16 v[160:175], v[84:87], v[104:107], v[160:175]
  v_xor_b32_sdwa v60, v4, v53 dst_sel:DWORD dst_unused:UNUSED_PAD src0_sel:DWORD src1_sel:WORD_1
  ds_read_b128 v[96:99], v60 offset:0
  v_xor_b32_sdwa v61, v4, v57 dst_sel:DWORD dst_unused:UNUSED_PAD src0_sel:DWORD src1_sel:WORD_1
  ds_read_b128 v[100:103], v61 offset:0
  v_mfma_f32_32x32x16_bf16 v[176:191], v[84:87], v[108:111], v[176:191]
  s_waitcnt lgkmcnt(2)
  s_add_u32 m0, s95, 6144
  s_add_u32 s98, s73, 212992
  buffer_load_dwordx4 v32, s[12:15], s98 offen lds
  v_mfma_f32_32x32x16_bf16 v[192:207], v[88:91], v[104:107], v[192:207]
  s_add_u32 m0, s95, 7168
  s_nop 0
  buffer_load_dwordx4 v33, s[12:15], s98 offen lds
  v_mfma_f32_32x32x16_bf16 v[208:223], v[88:91], v[108:111], v[208:223]
  s_add_u32 m0, s95, 8192
  s_nop 0
  buffer_load_dwordx4 v34, s[12:15], s98 offen lds
  s_waitcnt vmcnt(7) lgkmcnt(0)
  v_mfma_f32_32x32x16_bf16 v[128:143], v[64:67], v[96:99], v[128:143]
  ds_read_b64_tr_b16 v[80:81], v6 offset:0
  ds_read_b64_tr_b16 v[82:83], v6 offset:768
  ds_read_b64_tr_b16 v[84:85], v6 offset:64
  v_mfma_f32_32x32x16_bf16 v[144:159], v[64:67], v[100:103], v[144:159]
  ds_read_b64_tr_b16 v[86:87], v6 offset:832
  ds_read_b64_tr_b16 v[88:89], v6 offset:128
  ds_read_b64_tr_b16 v[90:91], v6 offset:896
  v_mfma_f32_32x32x16_bf16 v[160:175], v[68:71], v[96:99], v[160:175]
  v_xor_b32_sdwa v60, v4, v113 dst_sel:DWORD dst_unused:UNUSED_PAD src0_sel:DWORD src1_sel:WORD_1
  ds_read_b128 v[104:107], v60 offset:0
  v_xor_b32_sdwa v61, v4, v117 dst_sel:DWORD dst_unused:UNUSED_PAD src0_sel:DWORD src1_sel:WORD_1
  ds_read_b128 v[108:111], v61 offset:0
  v_mfma_f32_32x32x16_bf16 v[176:191], v[68:71], v[100:103], v[176:191]
  s_waitcnt lgkmcnt(2)
  s_add_u32 m0, s95, 0
  s_add_u32 s98, s74, 212992
  buffer_load_dwordx4 v32, s[12:15], s98 offen lds
  v_mfma_f32_32x32x16_bf16 v[192:207], v[72:75], v[96:99], v[192:207]
  s_add_u32 m0, s95, 1024
  s_nop 0
  buffer_load_dwordx4 v33, s[12:15], s98 offen lds
  v_mfma_f32_32x32x16_bf16 v[208:223], v[72:75], v[100:103], v[208:223]
  s_add_u32 m0, s95, 2048
  s_nop 0
  buffer_load_dwordx4 v34, s[12:15], s98 offen lds
  s_waitcnt vmcnt(6) lgkmcnt(0)
  v_mfma_f32_32x32x16_bf16 v[128:143], v[80:83], v[104:107], v[128:143]
  ds_read_b64_tr_b16 v[64:65], v6 offset:3072
  ds_read_b64_tr_b16 v[66:67], v6 offset:3840
  ds_read_b64_tr_b16 v[68:69], v6 offset:3136
  ds_read_b64_tr_b16 v[70:71], v6 offset:3904
  v_mfma_f32_32x32x16_bf16 v[144:159], v[80:83], v[108:111], v[144:159]
  ds_read_b64_tr_b16 v[72:73], v6 offset:3200
  ds_read_b64_tr_b16 v[74:75], v6 offset:3968
  ds_read_b64_tr_b16 v[76:77], v7 offset:9216
  ds_read_b64_tr_b16 v[78:79], v7 offset:9472
  v_mfma_f32_32x32x16_bf16 v[160:175], v[84:87], v[104:107], v[160:175]
  v_xor_b32_sdwa v60, v4, v38 dst_sel:DWORD dst_unused:UNUSED_PAD src0_sel:DWORD src1_sel:WORD_0
  ds_read_b128 v[96:99], v60 offset:0
  v_xor_b32_sdwa v61, v4, v42 dst_sel:DWORD dst_unused:UNUSED_PAD src0_sel:DWORD src1_sel:WORD_0
  ds_read_b128 v[100:103], v61 offset:0
  v_mfma_f32_32x32x16_bf16 v[176:191], v[84:87], v[108:111], v[176:191]
  s_waitcnt lgkmcnt(2)
  s_add_u32 m0, s95, 3072
  s_add_u32 s98, s75, 212992
  buffer_load_dwordx4 v32, s[12:15], s98 offen lds
  v_mfma_f32_32x32x16_bf16 v[192:207], v[88:91], v[104:107], v[192:207]
  s_add_u32 m0, s95, 4096
  s_nop 0
  buffer_load_dwordx4 v33, s[12:15], s98 offen lds
  v_mfma_f32_32x32x16_bf16 v[208:223], v[88:91], v[108:111], v[208:223]
  s_add_u32 m0, s95, 5120
  s_nop 0
  buffer_load_dwordx4 v34, s[12:15], s98 offen lds
  s_waitcnt vmcnt(6) lgkmcnt(0)
  v_mfma_f32_32x32x16_bf16 v[128:143], v[64:67], v[96:99], v[128:143]
  ds_read_b64_tr_b16 v[80:81], v6 offset:6144
  ds_read_b64_tr_b16 v[82:83], v6 offset:6912
  ds_read_b64_tr_b16 v[84:85], v6 offset:6208
  v_mfma_f32_32x32x16_bf16 v[144:159], v[64:67], v[100:103], v[144:159]
  ds_read_b64_tr_b16 v[86:87], v6 offset:6976
  ds_read_b64_tr_b16 v[88:89], v6 offset:6272
  ds_read_b64_tr_b16 v[90:91], v6 offset:7040
  v_mfma_f32_32x32x16_bf16 v[160:175], v[68:71], v[96:99], v[160:175]
  v_xor_b32_sdwa v60, v4, v46 dst_sel:DWORD dst_unused:UNUSED_PAD src0_sel:DWORD src1_sel:WORD_0
  ds_read_b128 v[104:107], v60 offset:0
  v_xor_b32_sdwa v61, v4, v50 dst_sel:DWORD dst_unused:UNUSED_PAD src0_sel:DWORD src1_sel:WORD_0
  ds_read_b128 v[108:111], v61 offset:0
  v_mfma_f32_32x32x16_bf16 v[176:191], v[68:71], v[100:103], v[176:191]
  v_mfma_f32_32x32x16_bf16 v[192:207], v[72:75], v[96:99], v[192:207]
  v_mfma_f32_32x32x16_bf16 v[208:223], v[72:75], v[100:103], v[208:223]
  s_waitcnt lgkmcnt(2)
  s_add_u32 m0, s95, 9216
  s_add_u32 s98, s72, 266240
  buffer_load_dwordx4 v35, s[12:15], s98 offen lds
  s_add_u32 m0, s95, 6144
  s_nop 0
  buffer_load_dwordx4 v32, s[12:15], s98 offen lds
  v_mfma_f32_32x32x16_bf16 v[224:239], v[76:79], v[96:99], v[224:239]
  s_add_u32 m0, s95, 7168
  s_nop 0
  buffer_load_dwordx4 v33, s[12:15], s98 offen lds
  v_mfma_f32_32x32x16_bf16 v[240:255], v[76:79], v[100:103], v[240:255]
  s_add_u32 m0, s95, 8192
  s_nop 0
  buffer_load_dwordx4 v34, s[12:15], s98 offen lds
  s_waitcnt vmcnt(7) lgkmcnt(0)
  v_mfma_f32_32x32x16_bf16 v[128:143], v[80:83], v[104:107], v[128:143]
  ds_read_b64_tr_b16 v[64:65], v6 offset:0
  ds_read_b64_tr_b16 v[66:67], v6 offset:768
  ds_read_b64_tr_b16 v[68:69], v6 offset:64
  v_mfma_f32_32x32x16_bf16 v[144:159], v[80:83], v[108:111], v[144:159]
  ds_read_b64_tr_b16 v[70:71], v6 offset:832
  ds_read_b64_tr_b16 v[72:73], v6 offset:128
  ds_read_b64_tr_b16 v[74:75], v6 offset:896
  v_mfma_f32_32x32x16_bf16 v[160:175], v[84:87], v[104:107], v[160:175]
  v_xor_b32_sdwa v60, v4, v54 dst_sel:DWORD dst_unused:UNUSED_PAD src0_sel:DWORD src1_sel:WORD_0
  ds_read_b128 v[96:99], v60 offset:0
  v_xor_b32_sdwa v61, v4, v58 dst_sel:DWORD dst_unused:UNUSED_PAD src0_sel:DWORD src1_sel:WORD_0
  ds_read_b128 v[100:103], v61 offset:0
  v_mfma_f32_32x32x16_bf16 v[176:191], v[84:87], v[108:111], v[176:191]
  s_waitcnt lgkmcnt(2)
  s_add_u32 m0, s95, 0
  s_add_u32 s98, s73, 266240
  buffer_load_dwordx4 v32, s[12:15], s98 offen lds
  v_mfma_f32_32x32x16_bf16 v[192:207], v[88:91], v[104:107], v[192:207]
  s_add_u32 m0, s95, 1024
  s_nop 0
  buffer_load_dwordx4 v33, s[12:15], s98 offen lds
  v_mfma_f32_32x32x16_bf16 v[208:223], v[88:91], v[108:111], v[208:223]
  s_add_u32 m0, s95, 2048
  s_nop 0
  buffer_load_dwordx4 v34, s[12:15], s98 offen lds
  s_waitcnt vmcnt(7) lgkmcnt(0)
  v_mfma_f32_32x32x16_bf16 v[128:143], v[64:67], v[96:99], v[128:143]
  ds_read_b64_tr_b16 v[80:81], v6 offset:3072
  ds_read_b64_tr_b16 v[82:83], v6 offset:3840
  ds_read_b64_tr_b16 v[84:85], v6 offset:3136
  v_mfma_f32_32x32x16_bf16 v[144:159], v[64:67], v[100:103], v[144:159]
  ds_read_b64_tr_b16 v[86:87], v6 offset:3904
  ds_read_b64_tr_b16 v[88:89], v6 offset:3200
  ds_read_b64_tr_b16 v[90:91], v6 offset:3968
  v_mfma_f32_32x32x16_bf16 v[160:175], v[68:71], v[96:99], v[160:175]
  v_xor_b32_sdwa v60, v4, v114 dst_sel:DWORD dst_unused:UNUSED_PAD src0_sel:DWORD src1_sel:WORD_0
  ds_read_b128 v[104:107], v60 offset:0
  v_xor_b32_sdwa v61, v4, v118 dst_sel:DWORD dst_unused:UNUSED_PAD src0_sel:DWORD src1_sel:WORD_0
  ds_read_b128 v[108:111], v61 offset:0
  v_mfma_f32_32x32x16_bf16 v[176:191], v[68:71], v[100:103], v[176:191]
  s_waitcnt lgkmcnt(2)
  s_add_u32 m0, s95, 3072
  s_add_u32 s98, s74, 266240
  buffer_load_dwordx4 v32, s[12:15], s98 offen lds
  v_mfma_f32_32x32x16_bf16 v[192:207], v[72:75], v[96:99], v[192:207]
  s_add_u32 m0, s95, 4096
  s_nop 0
  buffer_load_dwordx4 v33, s[12:15], s98 offen lds
  v_mfma_f32_32x32x16_bf16 v[208:223], v[72:75], v[100:103], v[208:223]
  s_add_u32 m0, s95, 5120
  s_nop 0
  buffer_load_dwordx4 v34, s[12:15], s98 offen lds
  s_waitcnt vmcnt(6) lgkmcnt(0)
  v_mfma_f32_32x32x16_bf16 v[128:143], v[80:83], v[104:107], v[128:143]
  ds_read_b64_tr_b16 v[64:65], v6 offset:6144
  ds_read_b64_tr_b16 v[66:67], v6 offset:6912
  ds_read_b64_tr_b16 v[68:69], v6 offset:6208
  ds_read_b64_tr_b16 v[70:71], v6 offset:6976
  v_mfma_f32_32x32x16_bf16 v[144:159], v[80:83], v[108:111], v[144:159]
  ds_read_b64_tr_b16 v[72:73], v6 offset:6272
  ds_read_b64_tr_b16 v[74:75], v6 offset:7040
  ds_read_b64_tr_b16 v[76:77], v7 offset:9216
  ds_read_b64_tr_b16 v[78:79], v7 offset:9472
  v_mfma_f32_32x32x16_bf16 v[160:175], v[84:87], v[104:107], v[160:175]
  v_xor_b32_sdwa v60, v4, v38 dst_sel:DWORD dst_unused:UNUSED_PAD src0_sel:DWORD src1_sel:WORD_1
  ds_read_b128 v[96:99], v60 offset:0
  v_xor_b32_sdwa v61, v4, v42 dst_sel:DWORD dst_unused:UNUSED_PAD src0_sel:DWORD src1_sel:WORD_1
  ds_read_b128 v[100:103], v61 offset:0
  v_mfma_f32_32x32x16_bf16 v[176:191], v[84:87], v[108:111], v[176:191]
  s_waitcnt lgkmcnt(2)
  s_add_u32 m0, s95, 6144
  s_add_u32 s98, s75, 266240
  buffer_load_dwordx4 v32, s[12:15], s98 offen lds
  v_mfma_f32_32x32x16_bf16 v[192:207], v[88:91], v[104:107], v[192:207]
  s_add_u32 m0, s95, 7168
  s_nop 0
  buffer_load_dwordx4 v33, s[12:15], s98 offen lds
  v_mfma_f32_32x32x16_bf16 v[208:223], v[88:91], v[108:111], v[208:223]
  s_add_u32 m0, s95, 8192
  s_nop 0
  buffer_load_dwordx4 v34, s[12:15], s98 offen lds
  s_waitcnt vmcnt(6) lgkmcnt(0)
  v_mfma_f32_32x32x16_bf16 v[128:143], v[64:67], v[96:99], v[128:143]
  ds_read_b64_tr_b16 v[80:81], v6 offset:0
  ds_read_b64_tr_b16 v[82:83], v6 offset:768
  ds_read_b64_tr_b16 v[84:85], v6 offset:64
  v_mfma_f32_32x32x16_bf16 v[144:159], v[64:67], v[100:103], v[144:159]
  ds_read_b64_tr_b16 v[86:87], v6 offset:832
  ds_read_b64_tr_b16 v[88:89], v6 offset:128
  ds_read_b64_tr_b16 v[90:91], v6 offset:896
  v_mfma_f32_32x32x16_bf16 v[160:175], v[68:71], v[96:99], v[160:175]
  v_xor_b32_sdwa v60, v4, v46 dst_sel:DWORD dst_unused:UNUSED_PAD src0_sel:DWORD src1_sel:WORD_1
  ds_read_b128 v[104:107], v60 offset:0
  v_xor_b32_sdwa v61, v4, v50 dst_sel:DWORD dst_unused:UNUSED_PAD src0_sel:DWORD src1_sel:WORD_1
  ds_read_b128 v[108:111], v61 offset:0
  v_mfma_f32_32x32x16_bf16 v[176:191], v[68:71], v[100:103], v[176:191]
  v_mfma_f32_32x32x16_bf16 v[192:207], v[72:75], v[96:99], v[192:207]
  v_mfma_f32_32x32x16_bf16 v[208:223], v[72:75], v[100:103], v[208:223]
  s_waitcnt lgkmcnt(2)
  s_add_u32 m0, s95, 9216
  s_mov_b32 s98, s76
  buffer_load_dwordx4 v35, s[12:15], s98 offen lds
  s_add_u32 m0, s95, 0
  s_nop 0
  buffer_load_dwordx4 v32, s[12:15], s98 offen lds
  v_mfma_f32_32x32x16_bf16 v[224:239], v[76:79], v[96:99], v[224:239]
  s_add_u32 m0, s95, 1024
  s_nop 0
  buffer_load_dwordx4 v33, s[12:15], s98 offen lds
  v_mfma_f32_32x32x16_bf16 v[240:255], v[76:79], v[100:103], v[240:255]
  s_add_u32 m0, s95, 2048
  s_nop 0
  buffer_load_dwordx4 v34, s[12:15], s98 offen lds
  s_waitcnt vmcnt(7) lgkmcnt(0)
  v_mfma_f32_32x32x16_bf16 v[128:143], v[80:83], v[104:107], v[128:143]
  ds_read_b64_tr_b16 v[64:65], v6 offset:3072
  ds_read_b64_tr_b16 v[66:67], v6 offset:3840
  ds_read_b64_tr_b16 v[68:69], v6 offset:3136
  v_mfma_f32_32x32x16_bf16 v[144:159], v[80:83], v[108:111], v[144:159]
  ds_read_b64_tr_b16 v[70:71], v6 offset:3904
  ds_read_b64_tr_b16 v[72:73], v6 offset:3200
  ds_read_b64_tr_b16 v[74:75], v6 offset:3968
  v_mfma_f32_32x32x16_bf16 v[160:175], v[84:87], v[104:107], v[160:175]
  v_xor_b32_sdwa v60, v4, v54 dst_sel:DWORD dst_unused:UNUSED_PAD src0_sel:DWORD src1_sel:WORD_1
  ds_read_b128 v[96:99], v60 offset:0
  v_xor_b32_sdwa v61, v4, v58 dst_sel:DWORD dst_unused:UNUSED_PAD src0_sel:DWORD src1_sel:WORD_1
  ds_read_b128 v[100:103], v61 offset:0
  v_mfma_f32_32x32x16_bf16 v[176:191], v[84:87], v[108:111], v[176:191]
  s_waitcnt lgkmcnt(2)
  s_add_u32 m0, s95, 3072
  s_mov_b32 s98, s77
  buffer_load_dwordx4 v32, s[12:15], s98 offen lds
  v_mfma_f32_32x32x16_bf16 v[192:207], v[88:91], v[104:107], v[192:207]
  s_add_u32 m0, s95, 4096
  s_nop 0
  buffer_load_dwordx4 v33, s[12:15], s98 offen lds
  v_mfma_f32_32x32x16_bf16 v[208:223], v[88:91], v[108:111], v[208:223]
  s_add_u32 m0, s95, 5120
  s_nop 0
  buffer_load_dwordx4 v34, s[12:15], s98 offen lds
  s_waitcnt vmcnt(7) lgkmcnt(0)
  v_mfma_f32_32x32x16_bf16 v[128:143], v[64:67], v[96:99], v[128:143]
  ds_read_b64_tr_b16 v[80:81], v6 offset:6144
  ds_read_b64_tr_b16 v[82:83], v6 offset:6912
  ds_read_b64_tr_b16 v[84:85], v6 offset:6208
  v_mfma_f32_32x32x16_bf16 v[144:159], v[64:67], v[100:103], v[144:159]
  ds_read_b64_tr_b16 v[86:87], v6 offset:6976
  ds_read_b64_tr_b16 v[88:89], v6 offset:6272
  ds_read_b64_tr_b16 v[90:91], v6 offset:7040
  v_mfma_f32_32x32x16_bf16 v[160:175], v[68:71], v[96:99], v[160:175]
  v_xor_b32_sdwa v60, v4, v114 dst_sel:DWORD dst_unused:UNUSED_PAD src0_sel:DWORD src1_sel:WORD_1
  ds_read_b128 v[104:107], v60 offset:0
  v_xor_b32_sdwa v61, v4, v118 dst_sel:DWORD dst_unused:UNUSED_PAD src0_sel:DWORD src1_sel:WORD_1
  ds_read_b128 v[108:111], v61 offset:0
  v_mfma_f32_32x32x16_bf16 v[176:191], v[68:71], v[100:103], v[176:191]
  v_mfma_f32_32x32x16_bf16 v[192:207], v[72:75], v[96:99], v[192:207]
  v_mfma_f32_32x32x16_bf16 v[208:223], v[72:75], v[100:103], v[208:223]
  s_waitcnt vmcnt(3) lgkmcnt(0)
  v_mfma_f32_32x32x16_bf16 v[128:143], v[80:83], v[104:107], v[128:143]
  ds_read_b64_tr_b16 v[64:65], v6 offset:0
  ds_read_b64_tr_b16 v[66:67], v6 offset:768
  ds_read_b64_tr_b16 v[68:69], v6 offset:64
  ds_read_b64_tr_b16 v[70:71], v6 offset:832
  v_mfma_f32_32x32x16_bf16 v[144:159], v[80:83], v[108:111], v[144:159]
  ds_read_b64_tr_b16 v[72:73], v6 offset:128
  ds_read_b64_tr_b16 v[74:75], v6 offset:896
  ds_read_b64_tr_b16 v[76:77], v7 offset:9216
  ds_read_b64_tr_b16 v[78:79], v7 offset:9472
  v_mfma_f32_32x32x16_bf16 v[160:175], v[84:87], v[104:107], v[160:175]
  v_xor_b32_sdwa v60, v4, v39 dst_sel:DWORD dst_unused:UNUSED_PAD src0_sel:DWORD src1_sel:WORD_0
  ds_read_b128 v[96:99], v60 offset:0
  v_xor_b32_sdwa v61, v4, v43 dst_sel:DWORD dst_unused:UNUSED_PAD src0_sel:DWORD src1_sel:WORD_0
  ds_read_b128 v[100:103], v61 offset:0
  v_mfma_f32_32x32x16_bf16 v[176:191], v[84:87], v[108:111], v[176:191]
  v_mfma_f32_32x32x16_bf16 v[192:207], v[88:91], v[104:107], v[192:207]
  v_mfma_f32_32x32x16_bf16 v[208:223], v[88:91], v[108:111], v[208:223]
  s_waitcnt vmcnt(0) lgkmcnt(0)
  v_mfma_f32_32x32x16_bf16 v[128:143], v[64:67], v[96:99], v[128:143]
  ds_read_b64_tr_b16 v[80:81], v6 offset:3072
  ds_read_b64_tr_b16 v[82:83], v6 offset:3840
  ds_read_b64_tr_b16 v[84:85], v6 offset:3136
  v_mfma_f32_32x32x16_bf16 v[144:159], v[64:67], v[100:103], v[144:159]
  ds_read_b64_tr_b16 v[86:87], v6 offset:3904
  ds_read_b64_tr_b16 v[88:89], v6 offset:3200
  ds_read_b64_tr_b16 v[90:91], v6 offset:3968
  v_mfma_f32_32x32x16_bf16 v[160:175], v[68:71], v[96:99], v[160:175]
  v_xor_b32_sdwa v60, v4, v47 dst_sel:DWORD dst_unused:UNUSED_PAD src0_sel:DWORD src1_sel:WORD_0
  ds_read_b128 v[104:107], v60 offset:0
  v_xor_b32_sdwa v61, v4, v51 dst_sel:DWORD dst_unused:UNUSED_PAD src0_sel:DWORD src1_sel:WORD_0
  ds_read_b128 v[108:111], v61 offset:0
  v_mfma_f32_32x32x16_bf16 v[176:191], v[68:71], v[100:103], v[176:191]
  v_mfma_f32_32x32x16_bf16 v[192:207], v[72:75], v[96:99], v[192:207]
  v_mfma_f32_32x32x16_bf16 v[208:223], v[72:75], v[100:103], v[208:223]
  s_cmp_ge_u32 s5, 2
  s_cbranch_scc1 SKIP12
  v_mfma_f32_32x32x16_bf16 v[224:239], v[76:79], v[96:99], v[224:239]
  v_mfma_f32_32x32x16_bf16 v[240:255], v[76:79], v[100:103], v[240:255]
SKIP12:
  s_waitcnt vmcnt(0) lgkmcnt(0)
  v_mfma_f32_32x32x16_bf16 v[128:143], v[80:83], v[104:107], v[128:143]
  v_mfma_f32_32x32x16_bf16 v[144:159], v[80:83], v[108:111], v[144:159]
  v_mfma_f32_32x32x16_bf16 v[160:175], v[84:87], v[104:107], v[160:175]
  v_mfma_f32_32x32x16_bf16 v[176:191], v[84:87], v[108:111], v[176:191]
  v_mfma_f32_32x32x16_bf16 v[192:207], v[88:91], v[104:107], v[192:207]
  v_mfma_f32_32x32x16_bf16 v[208:223], v[88:91], v[108:111], v[208:223]
  s_setprio 0
  v_lshl_add_u32 v8, v0, 4, s95
  s_nop 4
  ds_write_b128 v8, v[224:227] offset:0
  ds_write_b128 v8, v[228:231] offset:1024
  ds_write_b128 v8, v[232:235] offset:2048
  ds_write_b128 v8, v[236:239] offset:3072
  ds_write_b128 v8, v[240:243] offset:4096
  ds_write_b128 v8, v[244:247] offset:5120
  ds_write_b128 v8, v[248:251] offset:6144
  ds_write_b128 v8, v[252:255] offset:7168
  ds_write_b32 v28, v0 offset:42128
  s_mov_b32 s40, 0x3eeff558
  s_mov_b32 s41, 0x409d30fc
  s_mov_b32 s42, 0x71800000
  v_lshlrev_b32 v24, 16, v24
  v_lshlrev_b32 v25, 16, v25
  v_lshlrev_b32 v26, 16, v26
  v_lshlrev_b32 v27, 16, v27
  v_rcp_f32 v26, v26
  v_rcp_f32 v27, v27
  v_mul_f32 v24, s40, v24
  v_mul_f32 v25, s40, v25
  v_mul_f32 v26, s40, v26
  v_mul_f32 v27, s40, v27
  v_med3_f32 v26, v26, -s42, s42
  v_med3_f32 v27, v27, -s42, s42
  v_lshl_add_u32 v9, v0, 2, s95
  ds_write2st64_b32 v9, v24, v25 offset0:32 offset1:33
  ds_write2st64_b32 v9, v26, v27 offset0:34 offset1:35
  v_add_u32 v9, s95, v4
  ds_read_b128 v[64:67], v9 offset:8192
  ds_read_b128 v[80:83], v9 offset:8704
  ds_read_b128 v[68:71], v9 offset:8224
  ds_read_b128 v[84:87], v9 offset:8736
  ds_read_b128 v[72:75], v9 offset:8256
  ds_read_b128 v[88:91], v9 offset:8768
  ds_read_b128 v[76:79], v9 offset:8288
  ds_read_b128 v[92:95], v9 offset:8800
  .p2align 3
  s_waitcnt lgkmcnt(0)
  s_nop 0
  ds_read_b128 v[96:99], v9 offset:8320
  ds_read_b128 v[112:115], v9 offset:8832
  ds_read_b128 v[100:103], v9 offset:8352
  ds_read_b128 v[116:119], v9 offset:8864
  ds_read_b128 v[104:107], v9 offset:8384
  ds_read_b128 v[120:123], v9 offset:8896
  ds_read_b128 v[108:111], v9 offset:8416
  ds_read_b128 v[124:127], v9 offset:8928
  v_fma_f32 v128, v128, s40, v64
  v_fma_f32 v129, v129, s40, v65
  v_fma_f32 v130, v130, s40, v66
  v_fma_f32 v131, v131, s40, v67
  v_fma_f32 v40, v128, v128, s41
  v_fma_f32 v41, v129, v129, s41
  v_fma_f32 v42, v130, v130, s41
  v_fma_f32 v43, v131, v131, s41
  v_mul_f32 v40, v40, v128
  v_mul_f32 v41, v41, v129
  v_mul_f32 v42, v42, v130
  v_mul_f32 v43, v43, v131
  v_exp_f32 v40, -v40
  v_exp_f32 v41, -v41
  v_exp_f32 v42, -v42
  v_exp_f32 v43, -v43
  v_fma_f32 v40, v40, v80, v80
  v_fma_f32 v41, v41, v81, v81
  v_fma_f32 v42, v42, v82, v82
  v_fma_f32 v43, v43, v83, v83
  v_rcp_f32 v40, v40
  v_rcp_f32 v41, v41
  v_rcp_f32 v42, v42
  v_rcp_f32 v43, v43
  v_mul_f32 v44, v128, v40
  v_mul_f32 v45, v129, v41
  v_fmac_f32 v44, v130, v42
  v_fmac_f32 v45, v131, v43
  v_fma_f32 v132, v132, s40, v68
  v_fma_f32 v133, v133, s40, v69
  v_fma_f32 v134, v134, s40, v70
  v_fma_f32 v135, v135, s40, v71
  v_fma_f32 v40, v132, v132, s41
  v_fma_f32 v41, v133, v133, s41
  v_fma_f32 v42, v134, v134, s41
  v_fma_f32 v43, v135, v135, s41
  v_mul_f32 v40, v40, v132
  v_mul_f32 v41, v41, v133
  v_mul_f32 v42, v42, v134
  v_mul_f32 v43, v43, v135
  v_exp_f32 v40, -v40
  v_exp_f32 v41, -v41
  v_exp_f32 v42, -v42
  v_exp_f32 v43, -v43
  v_fma_f32 v40, v40, v84, v84
  v_fma_f32 v41, v41, v85, v85
  v_fma_f32 v42, v42, v86, v86
  v_fma_f32 v43, v43, v87, v87
  v_rcp_f32 v40, v40
  v_rcp_f32 v41, v41
  v_rcp_f32 v42, v42
  v_rcp_f32 v43, v43
  v_fmac_f32 v44, v132, v40
  v_fmac_f32 v45, v133, v41
  v_fmac_f32 v44, v134, v42
  v_fmac_f32 v45, v135, v43
  v_fma_f32 v136, v136, s40, v72
  v_fma_f32 v137, v137, s40, v73
  v_fma_f32 v138, v138, s40, v74
  v_fma_f32 v139, v139, s40, v75
  v_fma_f32 v40, v136, v136, s41
  v_fma_f32 v41, v137, v137, s41
  v_fma_f32 v42, v138, v138, s41
  v_fma_f32 v43, v139, v139, s41
  v_mul_f32 v40, v40, v136
  v_mul_f32 v41, v41, v137
  v_mul_f32 v42, v42, v138
  v_mul_f32 v43, v43, v139
  v_exp_f32 v40, -v40
  v_exp_f32 v41, -v41
  v_exp_f32 v42, -v42
  v_exp_f32 v43, -v43
  v_fma_f32 v40, v40, v88, v88
  v_fma_f32 v41, v41, v89, v89
  v_fma_f32 v42, v42, v90, v90
  v_fma_f32 v43, v43, v91, v91
  v_rcp_f32 v40, v40
  v_rcp_f32 v41, v41
  v_rcp_f32 v42, v42
  v_rcp_f32 v43, v43
  v_fmac_f32 v44, v136, v40
  v_fmac_f32 v45, v137, v41
  v_fmac_f32 v44, v138, v42
  v_fmac_f32 v45, v139, v43
  v_fma_f32 v140, v140, s40, v76
  v_fma_f32 v141, v141, s40, v77
  v_fma_f32 v142, v142, s40, v78
  v_fma_f32 v143, v143, s40, v79
  v_fma_f32 v40, v140, v140, s41
  v_fma_f32 v41, v141, v141, s41
  v_fma_f32 v42, v142, v142, s41
  v_fma_f32 v43, v143, v143, s41
  v_mul_f32 v40, v40, v140
  v_mul_f32 v41, v41, v141
  v_mul_f32 v42, v42, v142
  v_mul_f32 v43, v43, v143
  v_exp_f32 v40, -v40
  v_exp_f32 v41, -v41
  v_exp_f32 v42, -v42
  v_exp_f32 v43, -v43
  v_fma_f32 v40, v40, v92, v92
  v_fma_f32 v41, v41, v93, v93
  v_fma_f32 v42, v42, v94, v94
  v_fma_f32 v43, v43, v95, v95
  v_rcp_f32 v40, v40
  v_rcp_f32 v41, v41
  v_rcp_f32 v42, v42
  v_rcp_f32 v43, v43
  v_fmac_f32 v44, v140, v40
  v_fmac_f32 v45, v141, v41
  v_fmac_f32 v44, v142, v42
  v_fmac_f32 v45, v143, v43
  v_fma_f32 v144, v144, s40, v64
  v_fma_f32 v145, v145, s40, v65
  v_fma_f32 v146, v146, s40, v66
  v_fma_f32 v147, v147, s40, v67
  v_fma_f32 v40, v144, v144, s41
  v_fma_f32 v41, v145, v145, s41
  v_fma_f32 v42, v146, v146, s41
  v_fma_f32 v43, v147, v147, s41
  v_mul_f32 v40, v40, v144
  v_mul_f32 v41, v41, v145
  v_mul_f32 v42, v42, v146
  v_mul_f32 v43, v43, v147
  v_exp_f32 v40, -v40
  v_exp_f32 v41, -v41
  v_exp_f32 v42, -v42
  v_exp_f32 v43, -v43
  v_fma_f32 v40, v40, v80, v80
  v_fma_f32 v41, v41, v81, v81
  v_fma_f32 v42, v42, v82, v82
  v_fma_f32 v43, v43, v83, v83
  v_rcp_f32 v40, v40
  v_rcp_f32 v41, v41
  v_rcp_f32 v42, v42
  v_rcp_f32 v43, v43
  v_mul_f32 v46, v144, v40
  v_mul_f32 v47, v145, v41
  v_fmac_f32 v46, v146, v42
  v_fmac_f32 v47, v147, v43
  v_fma_f32 v148, v148, s40, v68
  v_fma_f32 v149, v149, s40, v69
  v_fma_f32 v150, v150, s40, v70
  v_fma_f32 v151, v151, s40, v71
  v_fma_f32 v40, v148, v148, s41
  v_fma_f32 v41, v149, v149, s41
  v_fma_f32 v42, v150, v150, s41
  v_fma_f32 v43, v151, v151, s41
  v_mul_f32 v40, v40, v148
  v_mul_f32 v41, v41, v149
  v_mul_f32 v42, v42, v150
  v_mul_f32 v43, v43, v151
  v_exp_f32 v40, -v40
  v_exp_f32 v41, -v41
  v_exp_f32 v42, -v42
  v_exp_f32 v43, -v43
  v_fma_f32 v40, v40, v84, v84
  v_fma_f32 v41, v41, v85, v85
  v_fma_f32 v42, v42, v86, v86
  v_fma_f32 v43, v43, v87, v87
  v_rcp_f32 v40, v40
  v_rcp_f32 v41, v41
  v_rcp_f32 v42, v42
  v_rcp_f32 v43, v43
  v_fmac_f32 v46, v148, v40
  v_fmac_f32 v47, v149, v41
  v_fmac_f32 v46, v150, v42
  v_fmac_f32 v47, v151, v43
  v_fma_f32 v152, v152, s40, v72
  v_fma_f32 v153, v153, s40, v73
  v_fma_f32 v154, v154, s40, v74
  v_fma_f32 v155, v155, s40, v75
  v_fma_f32 v40, v152, v152, s41
  v_fma_f32 v41, v153, v153, s41
  v_fma_f32 v42, v154, v154, s41
  v_fma_f32 v43, v155, v155, s41
  v_mul_f32 v40, v40, v152
  v_mul_f32 v41, v41, v153
  v_mul_f32 v42, v42, v154
  v_mul_f32 v43, v43, v155
  v_exp_f32 v40, -v40
  v_exp_f32 v41, -v41
  v_exp_f32 v42, -v42
  v_exp_f32 v43, -v43
  v_fma_f32 v40, v40, v88, v88
  v_fma_f32 v41, v41, v89, v89
  v_fma_f32 v42, v42, v90, v90
  v_fma_f32 v43, v43, v91, v91
  v_rcp_f32 v40, v40
  v_rcp_f32 v41, v41
  v_rcp_f32 v42, v42
  v_rcp_f32 v43, v43
  v_fmac_f32 v46, v152, v40
  v_fmac_f32 v47, v153, v41
  v_fmac_f32 v46, v154, v42
  v_fmac_f32 v47, v155, v43
  v_fma_f32 v156, v156, s40, v76
  v_fma_f32 v157, v157, s40, v77
  v_fma_f32 v158, v158, s40, v78
  v_fma_f32 v159, v159, s40, v79
  v_fma_f32 v40, v156, v156, s41
  v_fma_f32 v41, v157, v157, s41
  v_fma_f32 v42, v158, v158, s41
  v_fma_f32 v43, v159, v159, s41
  v_mul_f32 v40, v40, v156
  v_mul_f32 v41, v41, v157
  v_mul_f32 v42, v42, v158
  v_mul_f32 v43, v43, v159
  v_exp_f32 v40, -v40
  v_exp_f32 v41, -v41
  v_exp_f32 v42, -v42
  v_exp_f32 v43, -v43
  v_fma_f32 v40, v40, v92, v92
  v_fma_f32 v41, v41, v93, v93
  v_fma_f32 v42, v42, v94, v94
  v_fma_f32 v43, v43, v95, v95
  v_rcp_f32 v40, v40
  v_rcp_f32 v41, v41
  v_rcp_f32 v42, v42
  v_rcp_f32 v43, v43
  v_fmac_f32 v46, v156, v40
  v_fmac_f32 v47, v157, v41
  v_fmac_f32 v46, v158, v42
  v_fmac_f32 v47, v159, v43
  s_waitcnt lgkmcnt(0)
  s_nop 0
  ds_read_b128 v[64:67], v9 offset:8448
  ds_read_b128 v[80:83], v9 offset:8960
  ds_read_b128 v[68:71], v9 offset:8480
  ds_read_b128 v[84:87], v9 offset:8992
  ds_read_b128 v[72:75], v9 offset:8512
  ds_read_b128 v[88:91], v9 offset:9024
  ds_read_b128 v[76:79], v9 offset:8544
  ds_read_b128 v[92:95], v9 offset:9056
  v_fma_f32 v160, v160, s40, v96
  v_fma_f32 v161, v161, s40, v97
  v_fma_f32 v162, v162, s40, v98
  v_fma_f32 v163, v163, s40, v99
  v_fma_f32 v40, v160, v160, s41
  v_fma_f32 v41, v161, v161, s41
  v_fma_f32 v42, v162, v162, s41
  v_fma_f32 v43, v163, v163, s41
  v_mul_f32 v40, v40, v160
  v_mul_f32 v41, v41, v161
  v_mul_f32 v42, v42, v162
  v_mul_f32 v43, v43, v163
  v_exp_f32 v40, -v40
  v_exp_f32 v41, -v41
  v_exp_f32 v42, -v42
  v_exp_f32 v43, -v43
  v_fma_f32 v40, v40, v112, v112
  v_fma_f32 v41, v41, v113, v113
  v_fma_f32 v42, v42, v114, v114
  v_fma_f32 v43, v43, v115, v115
  v_rcp_f32 v40, v40
  v_rcp_f32 v41, v41
  v_rcp_f32 v42, v42
  v_rcp_f32 v43, v43
  v_fmac_f32 v44, v160, v40
  v_fmac_f32 v45, v161, v41
  v_fmac_f32 v44, v162, v42
  v_fmac_f32 v45, v163, v43
  v_fma_f32 v164, v164, s40, v100
  v_fma_f32 v165, v165, s40, v101
  v_fma_f32 v166, v166, s40, v102
  v_fma_f32 v167, v167, s40, v103
  v_fma_f32 v40, v164, v164, s41
  v_fma_f32 v41, v165, v165, s41
  v_fma_f32 v42, v166, v166, s41
  v_fma_f32 v43, v167, v167, s41
  v_mul_f32 v40, v40, v164
  v_mul_f32 v41, v41, v165
  v_mul_f32 v42, v42, v166
  v_mul_f32 v43, v43, v167
  v_exp_f32 v40, -v40
  v_exp_f32 v41, -v41
  v_exp_f32 v42, -v42
  v_exp_f32 v43, -v43
  v_fma_f32 v40, v40, v116, v116
  v_fma_f32 v41, v41, v117, v117
  v_fma_f32 v42, v42, v118, v118
  v_fma_f32 v43, v43, v119, v119
  v_rcp_f32 v40, v40
  v_rcp_f32 v41, v41
  v_rcp_f32 v42, v42
  v_rcp_f32 v43, v43
  v_fmac_f32 v44, v164, v40
  v_fmac_f32 v45, v165, v41
  v_fmac_f32 v44, v166, v42
  v_fmac_f32 v45, v167, v43
  v_fma_f32 v168, v168, s40, v104
  v_fma_f32 v169, v169, s40, v105
  v_fma_f32 v170, v170, s40, v106
  v_fma_f32 v171, v171, s40, v107
  v_fma_f32 v40, v168, v168, s41
  v_fma_f32 v41, v169, v169, s41
  v_fma_f32 v42, v170, v170, s41
  v_fma_f32 v43, v171, v171, s41
  v_mul_f32 v40, v40, v168
  v_mul_f32 v41, v41, v169
  v_mul_f32 v42, v42, v170
  v_mul_f32 v43, v43, v171
  v_exp_f32 v40, -v40
  v_exp_f32 v41, -v41
  v_exp_f32 v42, -v42
  v_exp_f32 v43, -v43
  v_fma_f32 v40, v40, v120, v120
  v_fma_f32 v41, v41, v121, v121
  v_fma_f32 v42, v42, v122, v122
  v_fma_f32 v43, v43, v123, v123
  v_rcp_f32 v40, v40
  v_rcp_f32 v41, v41
  v_rcp_f32 v42, v42
  v_rcp_f32 v43, v43
  v_fmac_f32 v44, v168, v40
  v_fmac_f32 v45, v169, v41
  v_fmac_f32 v44, v170, v42
  v_fmac_f32 v45, v171, v43
  v_fma_f32 v172, v172, s40, v108
  v_fma_f32 v173, v173, s40, v109
  v_fma_f32 v174, v174, s40, v110
  v_fma_f32 v175, v175, s40, v111
  v_fma_f32 v40, v172, v172, s41
  v_fma_f32 v41, v173, v173, s41
  v_fma_f32 v42, v174, v174, s41
  v_fma_f32 v43, v175, v175, s41
  v_mul_f32 v40, v40, v172
  v_mul_f32 v41, v41, v173
  v_mul_f32 v42, v42, v174
  v_mul_f32 v43, v43, v175
  v_exp_f32 v40, -v40
  v_exp_f32 v41, -v41
  v_exp_f32 v42, -v42
  v_exp_f32 v43, -v43
  v_fma_f32 v40, v40, v124, v124
  v_fma_f32 v41, v41, v125, v125
  v_fma_f32 v42, v42, v126, v126
  v_fma_f32 v43, v43, v127, v127
  v_rcp_f32 v40, v40
  v_rcp_f32 v41, v41
  v_rcp_f32 v42, v42
  v_rcp_f32 v43, v43
  v_fmac_f32 v44, v172, v40
  v_fmac_f32 v45, v173, v41
  v_fmac_f32 v44, v174, v42
  v_fmac_f32 v45, v175, v43
  v_fma_f32 v176, v176, s40, v96
  v_fma_f32 v177, v177, s40, v97
  v_fma_f32 v178, v178, s40, v98
  v_fma_f32 v179, v179, s40, v99
  v_fma_f32 v40, v176, v176, s41
  v_fma_f32 v41, v177, v177, s41
  v_fma_f32 v42, v178, v178, s41
  v_fma_f32 v43, v179, v179, s41
  v_mul_f32 v40, v40, v176
  v_mul_f32 v41, v41, v177
  v_mul_f32 v42, v42, v178
  v_mul_f32 v43, v43, v179
  v_exp_f32 v40, -v40
  v_exp_f32 v41, -v41
  v_exp_f32 v42, -v42
  v_exp_f32 v43, -v43
  v_fma_f32 v40, v40, v112, v112
  v_fma_f32 v41, v41, v113, v113
  v_fma_f32 v42, v42, v114, v114
  v_fma_f32 v43, v43, v115, v115
  v_rcp_f32 v40, v40
  v_rcp_f32 v41, v41
  v_rcp_f32 v42, v42
  v_rcp_f32 v43, v43
  v_fmac_f32 v46, v176, v40
  v_fmac_f32 v47, v177, v41
  v_fmac_f32 v46, v178, v42
  v_fmac_f32 v47, v179, v43
  v_fma_f32 v180, v180, s40, v100
  v_fma_f32 v181, v181, s40, v101
  v_fma_f32 v182, v182, s40, v102
  v_fma_f32 v183, v183, s40, v103
  v_fma_f32 v40, v180, v180, s41
  v_fma_f32 v41, v181, v181, s41
  v_fma_f32 v42, v182, v182, s41
  v_fma_f32 v43, v183, v183, s41
  v_mul_f32 v40, v40, v180
  v_mul_f32 v41, v41, v181
  v_mul_f32 v42, v42, v182
  v_mul_f32 v43, v43, v183
  v_exp_f32 v40, -v40
  v_exp_f32 v41, -v41
  v_exp_f32 v42, -v42
  v_exp_f32 v43, -v43
  v_fma_f32 v40, v40, v116, v116
  v_fma_f32 v41, v41, v117, v117
  v_fma_f32 v42, v42, v118, v118
  v_fma_f32 v43, v43, v119, v119
  v_rcp_f32 v40, v40
  v_rcp_f32 v41, v41
  v_rcp_f32 v42, v42
  v_rcp_f32 v43, v43
  v_fmac_f32 v46, v180, v40
  v_fmac_f32 v47, v181, v41
  v_fmac_f32 v46, v182, v42
  v_fmac_f32 v47, v183, v43
  v_fma_f32 v184, v184, s40, v104
  v_fma_f32 v185, v185, s40, v105
  v_fma_f32 v186, v186, s40, v106
  v_fma_f32 v187, v187, s40, v107
  v_fma_f32 v40, v184, v184, s41
  v_fma_f32 v41, v185, v185, s41
  v_fma_f32 v42, v186, v186, s41
  v_fma_f32 v43, v187, v187, s41
  v_mul_f32 v40, v40, v184
  v_mul_f32 v41, v41, v185
  v_mul_f32 v42, v42, v186
  v_mul_f32 v43, v43, v187
  v_exp_f32 v40, -v40
  v_exp_f32 v41, -v41
  v_exp_f32 v42, -v42
  v_exp_f32 v43, -v43
  v_fma_f32 v40, v40, v120, v120
  v_fma_f32 v41, v41, v121, v121
  v_fma_f32 v42, v42, v122, v122
  v_fma_f32 v43, v43, v123, v123
  v_rcp_f32 v40, v40
  v_rcp_f32 v41, v41
  v_rcp_f32 v42, v42
  v_rcp_f32 v43, v43
  v_fmac_f32 v46, v184, v40
  v_fmac_f32 v47, v185, v41
  v_fmac_f32 v46, v186, v42
  v_fmac_f32 v47, v187, v43
  v_fma_f32 v188, v188, s40, v108
  v_fma_f32 v189, v189, s40, v109
  v_fma_f32 v190, v190, s40, v110
  v_fma_f32 v191, v191, s40, v111
  v_fma_f32 v40, v188, v188, s41
  v_fma_f32 v41, v189, v189, s41
  v_fma_f32 v42, v190, v190, s41
  v_fma_f32 v43, v191, v191, s41
  v_mul_f32 v40, v40, v188
  v_mul_f32 v41, v41, v189
  v_mul_f32 v42, v42, v190
  v_mul_f32 v43, v43, v191
  v_exp_f32 v40, -v40
  v_exp_f32 v41, -v41
  v_exp_f32 v42, -v42
  v_exp_f32 v43, -v43
  v_fma_f32 v40, v40, v124, v124
  v_fma_f32 v41, v41, v125, v125
  v_fma_f32 v42, v42, v126, v126
  v_fma_f32 v43, v43, v127, v127
  v_rcp_f32 v40, v40
  v_rcp_f32 v41, v41
  v_rcp_f32 v42, v42
  v_rcp_f32 v43, v43
  v_fmac_f32 v46, v188, v40
  v_fmac_f32 v47, v189, v41
  v_fmac_f32 v46, v190, v42
  v_fmac_f32 v47, v191, v43
  s_waitcnt lgkmcnt(0)
  s_nop 0
  v_fma_f32 v192, v192, s40, v64
  v_fma_f32 v193, v193, s40, v65
  v_fma_f32 v194, v194, s40, v66
  v_fma_f32 v195, v195, s40, v67
  v_fma_f32 v40, v192, v192, s41
  v_fma_f32 v41, v193, v193, s41
  v_fma_f32 v42, v194, v194, s41
  v_fma_f32 v43, v195, v195, s41
  v_mul_f32 v40, v40, v192
  v_mul_f32 v41, v41, v193
  v_mul_f32 v42, v42, v194
  v_mul_f32 v43, v43, v195
  v_exp_f32 v40, -v40
  v_exp_f32 v41, -v41
  v_exp_f32 v42, -v42
  v_exp_f32 v43, -v43
  v_fma_f32 v40, v40, v80, v80
  v_fma_f32 v41, v41, v81, v81
  v_fma_f32 v42, v42, v82, v82
  v_fma_f32 v43, v43, v83, v83
  v_rcp_f32 v40, v40
  v_rcp_f32 v41, v41
  v_rcp_f32 v42, v42
  v_rcp_f32 v43, v43
  v_fmac_f32 v44, v192, v40
  v_fmac_f32 v45, v193, v41
  v_fmac_f32 v44, v194, v42
  v_fmac_f32 v45, v195, v43
  v_fma_f32 v196, v196, s40, v68
  v_fma_f32 v197, v197, s40, v69
  v_fma_f32 v198, v198, s40, v70
  v_fma_f32 v199, v199, s40, v71
  v_fma_f32 v40, v196, v196, s41
  v_fma_f32 v41, v197, v197, s41
  v_fma_f32 v42, v198, v198, s41
  v_fma_f32 v43, v199, v199, s41
  v_mul_f32 v40, v40, v196
  v_mul_f32 v41, v41, v197
  v_mul_f32 v42, v42, v198
  v_mul_f32 v43, v43, v199
  v_exp_f32 v40, -v40
  v_exp_f32 v41, -v41
  v_exp_f32 v42, -v42
  v_exp_f32 v43, -v43
  v_fma_f32 v40, v40, v84, v84
  v_fma_f32 v41, v41, v85, v85
  v_fma_f32 v42, v42, v86, v86
  v_fma_f32 v43, v43, v87, v87
  v_rcp_f32 v40, v40
  v_rcp_f32 v41, v41
  v_rcp_f32 v42, v42
  v_rcp_f32 v43, v43
  v_fmac_f32 v44, v196, v40
  v_fmac_f32 v45, v197, v41
  v_fmac_f32 v44, v198, v42
  v_fmac_f32 v45, v199, v43
  v_fma_f32 v200, v200, s40, v72
  v_fma_f32 v201, v201, s40, v73
  v_fma_f32 v202, v202, s40, v74
  v_fma_f32 v203, v203, s40, v75
  v_fma_f32 v40, v200, v200, s41
  v_fma_f32 v41, v201, v201, s41
  v_fma_f32 v42, v202, v202, s41
  v_fma_f32 v43, v203, v203, s41
  v_mul_f32 v40, v40, v200
  v_mul_f32 v41, v41, v201
  v_mul_f32 v42, v42, v202
  v_mul_f32 v43, v43, v203
  v_exp_f32 v40, -v40
  v_exp_f32 v41, -v41
  v_exp_f32 v42, -v42
  v_exp_f32 v43, -v43
  v_fma_f32 v40, v40, v88, v88
  v_fma_f32 v41, v41, v89, v89
  v_fma_f32 v42, v42, v90, v90
  v_fma_f32 v43, v43, v91, v91
  v_rcp_f32 v40, v40
  v_rcp_f32 v41, v41
  v_rcp_f32 v42, v42
  v_rcp_f32 v43, v43
  v_fmac_f32 v44, v200, v40
  v_fmac_f32 v45, v201, v41
  v_fmac_f32 v44, v202, v42
  v_fmac_f32 v45, v203, v43
  v_fma_f32 v204, v204, s40, v76
  v_fma_f32 v205, v205, s40, v77
  v_fma_f32 v206, v206, s40, v78
  v_fma_f32 v207, v207, s40, v79
  v_fma_f32 v40, v204, v204, s41
  v_fma_f32 v41, v205, v205, s41
  v_fma_f32 v42, v206, v206, s41
  v_fma_f32 v43, v207, v207, s41
  v_mul_f32 v40, v40, v204
  v_mul_f32 v41, v41, v205
  v_mul_f32 v42, v42, v206
  v_mul_f32 v43, v43, v207
  v_exp_f32 v40, -v40
  v_exp_f32 v41, -v41
  v_exp_f32 v42, -v42
  v_exp_f32 v43, -v43
  v_fma_f32 v40, v40, v92, v92
  v_fma_f32 v41, v41, v93, v93
  v_fma_f32 v42, v42, v94, v94
  v_fma_f32 v43, v43, v95, v95
  v_rcp_f32 v40, v40
  v_rcp_f32 v41, v41
  v_rcp_f32 v42, v42
  v_rcp_f32 v43, v43
  v_fmac_f32 v44, v204, v40
  v_fmac_f32 v45, v205, v41
  v_fmac_f32 v44, v206, v42
  v_fmac_f32 v45, v207, v43
  v_fma_f32 v208, v208, s40, v64
  v_fma_f32 v209, v209, s40, v65
  v_fma_f32 v210, v210, s40, v66
  v_fma_f32 v211, v211, s40, v67
  v_fma_f32 v40, v208, v208, s41
  v_fma_f32 v41, v209, v209, s41
  v_fma_f32 v42, v210, v210, s41
  v_fma_f32 v43, v211, v211, s41
  v_mul_f32 v40, v40, v208
  v_mul_f32 v41, v41, v209
  v_mul_f32 v42, v42, v210
  v_mul_f32 v43, v43, v211
  v_exp_f32 v40, -v40
  v_exp_f32 v41, -v41
  v_exp_f32 v42, -v42
  v_exp_f32 v43, -v43
  v_fma_f32 v40, v40, v80, v80
  v_fma_f32 v41, v41, v81, v81
  v_fma_f32 v42, v42, v82, v82
  v_fma_f32 v43, v43, v83, v83
  v_rcp_f32 v40, v40
  v_rcp_f32 v41, v41
  v_rcp_f32 v42, v42
  v_rcp_f32 v43, v43
  v_fmac_f32 v46, v208, v40
  v_fmac_f32 v47, v209, v41
  v_fmac_f32 v46, v210, v42
  v_fmac_f32 v47, v211, v43
  v_fma_f32 v212, v212, s40, v68
  v_fma_f32 v213, v213, s40, v69
  v_fma_f32 v214, v214, s40, v70
  v_fma_f32 v215, v215, s40, v71
  v_fma_f32 v40, v212, v212, s41
  v_fma_f32 v41, v213, v213, s41
  v_fma_f32 v42, v214, v214, s41
  v_fma_f32 v43, v215, v215, s41
  v_mul_f32 v40, v40, v212
  v_mul_f32 v41, v41, v213
  v_mul_f32 v42, v42, v214
  v_mul_f32 v43, v43, v215
  v_exp_f32 v40, -v40
  v_exp_f32 v41, -v41
  v_exp_f32 v42, -v42
  v_exp_f32 v43, -v43
  v_fma_f32 v40, v40, v84, v84
  v_fma_f32 v41, v41, v85, v85
  v_fma_f32 v42, v42, v86, v86
  v_fma_f32 v43, v43, v87, v87
  v_rcp_f32 v40, v40
  v_rcp_f32 v41, v41
  v_rcp_f32 v42, v42
  v_rcp_f32 v43, v43
  v_fmac_f32 v46, v212, v40
  v_fmac_f32 v47, v213, v41
  v_fmac_f32 v46, v214, v42
  v_fmac_f32 v47, v215, v43
  v_fma_f32 v216, v216, s40, v72
  v_fma_f32 v217, v217, s40, v73
  v_fma_f32 v218, v218, s40, v74
  v_fma_f32 v219, v219, s40, v75
  v_fma_f32 v40, v216, v216, s41
  v_fma_f32 v41, v217, v217, s41
  v_fma_f32 v42, v218, v218, s41
  v_fma_f32 v43, v219, v219, s41
  v_mul_f32 v40, v40, v216
  v_mul_f32 v41, v41, v217
  v_mul_f32 v42, v42, v218
  v_mul_f32 v43, v43, v219
  v_exp_f32 v40, -v40
  v_exp_f32 v41, -v41
  v_exp_f32 v42, -v42
  v_exp_f32 v43, -v43
  v_fma_f32 v40, v40, v88, v88
  v_fma_f32 v41, v41, v89, v89
  v_fma_f32 v42, v42, v90, v90
  v_fma_f32 v43, v43, v91, v91
  v_rcp_f32 v40, v40
  v_rcp_f32 v41, v41
  v_rcp_f32 v42, v42
  v_rcp_f32 v43, v43
  v_fmac_f32 v46, v216, v40
  v_fmac_f32 v47, v217, v41
  v_fmac_f32 v46, v218, v42
  v_fmac_f32 v47, v219, v43
  v_fma_f32 v220, v220, s40, v76
  v_fma_f32 v221, v221, s40, v77
  v_fma_f32 v222, v222, s40, v78
  v_fma_f32 v223, v223, s40, v79
  v_fma_f32 v40, v220, v220, s41
  v_fma_f32 v41, v221, v221, s41
  v_fma_f32 v42, v222, v222, s41
  v_fma_f32 v43, v223, v223, s41
  v_mul_f32 v40, v40, v220
  v_mul_f32 v41, v41, v221
  v_mul_f32 v42, v42, v222
  v_mul_f32 v43, v43, v223
  v_exp_f32 v40, -v40
  v_exp_f32 v41, -v41
  v_exp_f32 v42, -v42
  v_exp_f32 v43, -v43
  v_fma_f32 v40, v40, v92, v92
  v_fma_f32 v41, v41, v93, v93
  v_fma_f32 v42, v42, v94, v94
  v_fma_f32 v43, v43, v95, v95
  v_rcp_f32 v40, v40
  v_rcp_f32 v41, v41
  v_rcp_f32 v42, v42
  v_rcp_f32 v43, v43
  v_fmac_f32 v46, v220, v40
  v_fmac_f32 v47, v221, v41
  v_fmac_f32 v46, v222, v42
  v_fmac_f32 v47, v223, v43
  s_mov_b32 s91, 0x80000
  s_branch SW1_f
SW1:
  s_sleep 1
SW1_f:
  ds_read_b128 v[50:53], v3 offset:42128
  s_sub_u32 s91, s91, 1
  s_cbranch_scc1 SW1_x
  s_waitcnt lgkmcnt(0)
  v_min_u32 v54, v50, v51
  v_min3_u32 v54, v54, v52, v53
  s_nop 0
  v_readfirstlane_b32 s90, v54
  s_cmp_eq_u32 s90, 0
  s_cbranch_scc1 SW1
SW1_x:
  s_lshl_b32 s6, s5, 11
  s_add_u32 s6, s6, 118336
  v_lshl_add_u32 v8, v0, 4, s6
  s_and_b32 s6, s5, 1
  s_lshl_b32 s6, s6, 6
  v_add_u32 v9, s6, v9
  ds_read_b128 v[128:131], v8 offset:0
  ds_read_b128 v[132:135], v8 offset:1024
  ds_read_b128 v[136:139], v8 offset:10240
  ds_read_b128 v[140:143], v8 offset:11264
  ds_read_b128 v[144:147], v8 offset:20480
  ds_read_b128 v[148:151], v8 offset:21504
  ds_read_b128 v[152:155], v8 offset:30720
  ds_read_b128 v[156:159], v8 offset:31744
  ds_read_b128 v[96:99], v9 offset:8576
  ds_read_b128 v[112:115], v9 offset:9088
  ds_read_b128 v[100:103], v9 offset:8608
  ds_read_b128 v[116:119], v9 offset:9120
  s_waitcnt lgkmcnt(0)
  v_add_f32 v128, v128, v136
  v_add_f32 v144, v144, v152
  v_add_f32 v128, v128, v144
  v_add_f32 v129, v129, v137
  v_add_f32 v145, v145, v153
  v_add_f32 v129, v129, v145
  v_add_f32 v130, v130, v138
  v_add_f32 v146, v146, v154
  v_add_f32 v130, v130, v146
  v_add_f32 v131, v131, v139
  v_add_f32 v147, v147, v155
  v_add_f32 v131, v131, v147
  v_add_f32 v132, v132, v140
  v_add_f32 v148, v148, v156
  v_add_f32 v132, v132, v148
  v_add_f32 v133, v133, v141
  v_add_f32 v149, v149, v157
  v_add_f32 v133, v133, v149
  v_add_f32 v134, v134, v142
  v_add_f32 v150, v150, v158
  v_add_f32 v134, v134, v150
  v_add_f32 v135, v135, v143
  v_add_f32 v151, v151, v159
  v_add_f32 v135, v135, v151
  v_fma_f32 v128, v128, s40, v96
  v_fma_f32 v129, v129, s40, v97
  v_fma_f32 v130, v130, s40, v98
  v_fma_f32 v131, v131, s40, v99
  v_fma_f32 v40, v128, v128, s41
  v_fma_f32 v41, v129, v129, s41
  v_fma_f32 v42, v130, v130, s41
  v_fma_f32 v43, v131, v131, s41
  v_mul_f32 v40, v40, v128
  v_mul_f32 v41, v41, v129
  v_mul_f32 v42, v42, v130
  v_mul_f32 v43, v43, v131
  v_exp_f32 v40, -v40
  v_exp_f32 v41, -v41
  v_exp_f32 v42, -v42
  v_exp_f32 v43, -v43
  v_fma_f32 v40, v40, v112, v112
  v_fma_f32 v41, v41, v113, v113
  v_fma_f32 v42, v42, v114, v114
  v_fma_f32 v43, v43, v115, v115
  v_rcp_f32 v40, v40
  v_rcp_f32 v41, v41
  v_rcp_f32 v42, v42
  v_rcp_f32 v43, v43
  v_mul_f32 v48, v128, v40
  v_mul_f32 v49, v129, v41
  v_fmac_f32 v48, v130, v42
  v_fmac_f32 v49, v131, v43
  v_fma_f32 v132, v132, s40, v100
  v_fma_f32 v133, v133, s40, v101
  v_fma_f32 v134, v134, s40, v102
  v_fma_f32 v135, v135, s40, v103
  v_fma_f32 v40, v132, v132, s41
  v_fma_f32 v41, v133, v133, s41
  v_fma_f32 v42, v134, v134, s41
  v_fma_f32 v43, v135, v135, s41
  v_mul_f32 v40, v40, v132
  v_mul_f32 v41, v41, v133
  v_mul_f32 v42, v42, v134
  v_mul_f32 v43, v43, v135
  v_exp_f32 v40, -v40
  v_exp_f32 v41, -v41
  v_exp_f32 v42, -v42
  v_exp_f32 v43, -v43
  v_fma_f32 v40, v40, v116, v116
  v_fma_f32 v41, v41, v117, v117
  v_fma_f32 v42, v42, v118, v118
  v_fma_f32 v43, v43, v119, v119
  v_rcp_f32 v40, v40
  v_rcp_f32 v41, v41
  v_rcp_f32 v42, v42
  v_rcp_f32 v43, v43
  v_fmac_f32 v48, v132, v40
  v_fmac_f32 v49, v133, v41
  v_fmac_f32 v48, v134, v42
  v_fmac_f32 v49, v135, v43
  v_add_f32 v44, v44, v45
  v_add_f32 v46, v46, v47
  v_add_f32 v48, v48, v49
  s_cmp_ge_u32 s5, 2
  s_cselect_b32 s6, 0, 1.0
  s_cselect_b32 s7, 1.0, 0
  v_fmac_f32 v44, s6, v48
  v_fmac_f32 v46, s7, v48
  v_lshl_add_u32 v9, v0, 2, s95
  ds_write2st64_b32 v9, v44, v46 offset0:36 offset1:37
DEND:
  ds_write_b32 v28, v0 offset:42144
  s_waitcnt lgkmcnt(0)
END:
  s_endpgm
W2_:
  v_lshrrev_b32 v10, 2, v1
  v_cmp_lt_u32 vcc, 7, v1
  v_cmp_gt_u32 s[74:75], 10, v1
  v_cmp_eq_u32 s[68:69], 12, v1
  v_cmp_ge_u32 s[84:85], v10, v2
  v_and_b32 v11, 1, v1
  v_mul_u32_u24 v11, 400, v11
  v_bfe_u32 v12, v1, 1, 1
  v_lshrrev_b32 v13, 1, v2
  v_and_b32 v15, 1, v2
  v_add_u32 v14, 1, v10
  v_mul_u32_u24 v14, v14, v10
  v_lshrrev_b32 v14, 1, v14
  v_add_lshl_u32 v16, v14, v2, 4
  v_lshl_add_u32 v16, v12, 3, v16
  v_add_u32 v16, v16, v11
  v_cndmask_b32 v32, v31, v16, s[84:85]
  v_lshl_add_u32 v14, v10, 2, v14
  v_add_u32 v14, 10, v14
  v_cndmask_b32 v12, v12, v15, vcc
  v_cndmask_b32 v17, v2, v13, vcc
  v_cndmask_b32 v18, 64, 32, vcc
  v_add_lshl_u32 v16, v14, v17, 4
  v_lshl_add_u32 v16, v12, 3, v16
  v_add_u32 v16, v16, v11
  s_and_b64 s[84:85], s[84:85], s[74:75]
  v_cndmask_b32 v33, v31, v16, s[74:75]
  v_add_u32 v16, v16, v18
  v_cndmask_b32 v34, v31, v16, s[84:85]
  v_lshlrev_b32 v10, 3, v2
  v_sub_u32 v10, v1, v10
  v_mov_b32 v12, 0xffff
  v_mov_b32 v13, 0xffff0000
  v_cmp_eq_u32 vcc, 0, v10
  v_cmp_eq_u32 s[84:85], 1, v10
  s_nop 0
  v_cndmask_b32 v136, 0, v12, vcc
  v_cndmask_b32 v136, v136, v13, s[84:85]
  v_cmp_eq_u32 vcc, 2, v10
  v_cmp_eq_u32 s[84:85], 3, v10
  s_nop 0
  v_cndmask_b32 v137, 0, v12, vcc
  v_cndmask_b32 v137, v137, v13, s[84:85]
  v_cmp_eq_u32 vcc, 4, v10
  v_cmp_eq_u32 s[84:85], 5, v10
  s_nop 0
  v_cndmask_b32 v138, 0, v12, vcc
  v_cndmask_b32 v138, v138, v13, s[84:85]
  v_cmp_eq_u32 vcc, 6, v10
  v_cmp_eq_u32 s[84:85], 7, v10
  s_nop 0
  v_cndmask_b32 v139, 0, v12, vcc
  v_cndmask_b32 v139, v139, v13, s[84:85]
  v_cmp_eq_u32 vcc, -16, v10
  v_cmp_eq_u32 s[84:85], -15, v10
  s_nop 0
  v_cndmask_b32 v140, 0, v12, vcc
  v_cndmask_b32 v140, v140, v13, s[84:85]
  v_cndmask_b32 v140, 0, v140, s[74:75]
  v_cmp_eq_u32 vcc, -14, v10
  v_cmp_eq_u32 s[84:85], -13, v10
  s_nop 0
  v_cndmask_b32 v141, 0, v12, vcc
  v_cndmask_b32 v141, v141, v13, s[84:85]
  v_cndmask_b32 v141, 0, v141, s[74:75]
  v_cmp_eq_u32 vcc, -12, v10
  v_cmp_eq_u32 s[84:85], -11, v10
  s_nop 0
  v_cndmask_b32 v142, 0, v12, vcc
  v_cndmask_b32 v142, v142, v13, s[84:85]
  v_cndmask_b32 v142, 0, v142, s[74:75]
  v_cmp_eq_u32 vcc, -10, v10
  v_cmp_eq_u32 s[84:85], -9, v10
  s_nop 0
  v_cndmask_b32 v143, 0, v12, vcc
  v_cndmask_b32 v143, v143, v13, s[84:85]
  v_cndmask_b32 v143, 0, v143, s[74:75]
  s_waitcnt vmcnt(2)
  v_mfma_f32_16x16x32_bf16 v[60:63], v[120:123], v[120:123], 0
  s_nop 7
  v_max3_f32 v18, |v60|, |v61|, |v62|
  v_max_f32 v18, |v63|, v18
  v_or_b32 v18, 1, v18
  s_nop 1
  v_max_u32_dpp v18, v18, v18 row_shr:1 row_mask:0xf bank_mask:0xf
  s_nop 1
  v_max_u32_dpp v18, v18, v18 row_shr:2 row_mask:0xf bank_mask:0xf
  s_nop 1
  v_max_u32_dpp v18, v18, v18 row_shr:4 row_mask:0xf bank_mask:0xf
  s_nop 1
  v_max_u32_dpp v18, v18, v18 row_shr:8 row_mask:0xf bank_mask:0xf
  s_nop 1
  v_max_u32_dpp v18, v18, v18 row_bcast:15 row_mask:0xa bank_mask:0xf
  s_nop 1
  v_max_u32_dpp v18, v18, v18 row_bcast:31 row_mask:0xc bank_mask:0xf
  s_nop 0
  v_readlane_b32 s6, v18, 63
  s_lshr_b32 s6, s6, 23
  s_add_u32 s6, s6, 135
  s_lshr_b32 s6, s6, 1
  s_cmp_eq_u32 s71, 0
  s_cselect_b32 s71, s6, s71
  s_sub_i32 s6, 267, s71
  s_lshl_b32 s6, s6, 7
  s_mul_i32 s6, s6, 0x10001
  v_mov_b32 v96, s71
  v_and_b32 v144, s6, v136
  v_and_b32 v145, s6, v137
  v_and_b32 v146, s6, v138
  v_and_b32 v147, s6, v139
  v_and_b32 v148, s6, v140
  v_and_b32 v149, s6, v141
  v_and_b32 v150, s6, v142
  v_and_b32 v151, s6, v143
WJOB:
  s_waitcnt vmcnt(0)
  s_nop 0
  v_mfma_f32_16x16x32_bf16 v[72:75], v[112:115], v[144:147], 0
  v_mfma_f32_16x16x32_bf16 v[76:79], v[112:115], v[148:151], 0
  v_mfma_f32_16x16x32_bf16 v[72:75], v[144:147], v[112:115], v[72:75]
  v_mfma_f32_16x16x32_bf16 v[80:83], v[116:119], v[148:151], 0
  v_mfma_f32_16x16x32_bf16 v[76:79], v[144:147], v[116:119], v[76:79]
  v_mfma_f32_16x16x32_bf16 v[80:83], v[148:151], v[116:119], v[80:83]
  v_mfma_f32_16x16x32_bf16 v[56:59], v[112:115], v[112:115], 0
  v_mfma_f32_16x16x32_bf16 v[56:59], v[116:119], v[116:119], v[56:59]
  v_add_u32 v12, s98, v32
  v_add_u32 v13, s98, v33
  v_add_u32 v14, s98, v34
  v_and_b32 v17, 262144, v28
  v_add_u32 v17, s98, v17
  v_lshl_add_u32 v11, v0, 4, s98
  v_cvt_pk_f16_f32 v152, v72, v73
  v_cvt_pk_f16_f32 v153, v74, v75
  ds_write_b64 v12, v[152:153]
  v_cvt_pk_f16_f32 v154, v76, v77
  v_cvt_pk_f16_f32 v155, v78, v79
  ds_write_b64 v13, v[154:155]
  v_cvt_pk_f16_f32 v156, v80, v81
  v_cvt_pk_f16_f32 v157, v82, v83
  ds_write_b64 v14, v[156:157]
  v_max3_f32 v97, |v56|, |v57|, |v58|
  v_max_f32 v97, |v59|, v97
  v_or_b32 v97, 1, v97
  s_nop 1
  v_max_u32_dpp v97, v97, v97 row_shr:1 row_mask:0xf bank_mask:0xf
  s_nop 1
  v_max_u32_dpp v97, v97, v97 row_shr:2 row_mask:0xf bank_mask:0xf
  s_nop 1
  v_max_u32_dpp v97, v97, v97 row_shr:4 row_mask:0xf bank_mask:0xf
  s_nop 1
  v_max_u32_dpp v97, v97, v97 row_shr:8 row_mask:0xf bank_mask:0xf
  s_nop 1
  v_max_u32_dpp v97, v97, v97 row_bcast:15 row_mask:0xa bank_mask:0xf
  s_nop 1
  v_max_u32_dpp v97, v97, v97 row_bcast:31 row_mask:0xc bank_mask:0xf
  ds_write_b64 v17, v[96:97] offset:800
  s_cmp_lg_u32 s82, 0
  s_cbranch_scc1 WNEXT
  ds_read_b128 v[40:43], v11
  v_add_u32 v10, 974336, v11
  v_cmp_gt_u32 vcc, 51, v0
  s_mov_b32 s14, 4
  s_mov_b64 exec, vcc
  s_waitcnt lgkmcnt(0)
  global_store_dwordx4 v10, v[40:43], s[100:101] sc0 sc1
  s_mov_b64 exec, -1
  s_branch PRET
WNEXT:
  s_add_u32 s99, s99, 3
  s_cmp_gt_u32 s99, 25
  s_cbranch_scc1 WEND
  s_mul_i32 s11, s99, 1352
  s_mul_i32 s98, s99, 816
  s_add_u32 s98, s98, 74240
  buffer_load_dwordx4 v[112:115], v20, s[36:39], s11 offen
  buffer_load_dwordx4 v[116:119], v20, s[36:39], s11 offen offset:832
  s_branch WJOB
WEND:
  s_add_u32 s95, s95, 4
  v_mov_b32 v10, 1
  v_and_b32 v11, 262144, v28
  s_waitcnt vmcnt(0) lgkmcnt(0)
  ds_add_u32 v11, v10 offset:42160
  s_mov_b32 s91, 0x80000
AB2:
  ds_read_b32 v10, v3 offset:42160
  s_sub_u32 s91, s91, 1
  s_cbranch_scc1 AB2_x
  s_waitcnt lgkmcnt(0)
  v_readfirstlane_b32 s90, v10
  s_cmp_lt_u32 s90, s95
  s_cbranch_scc1 AB2
AB2_x:
  s_branch PDONE
V2_:
  v_bfe_u32 v10, v0, 2, 2
  v_and_b32 v11, 3, v0
  v_lshl_add_u32 v14, v2, 3, v10
  v_cmp_eq_u32 s[60:61], 3, v11
  v_add_u32 v13, 0, v14
  v_cmp_lt_u32 vcc, 25, v13
  v_lshlrev_b32 v13, 6, v13
  v_lshl_add_u32 v13, v11, 3, v13
  v_add_u32 v13, s83, v13
  v_cndmask_b32 v212, v13, v31, vcc
  v_cndmask_b32 v214, v212, v31, s[60:61]
  v_add_u32 v13, 4, v14
  v_cmp_lt_u32 vcc, 25, v13
  v_lshlrev_b32 v13, 6, v13
  v_lshl_add_u32 v13, v11, 3, v13
  v_add_u32 v13, s83, v13
  v_cndmask_b32 v213, v13, v31, vcc
  v_cndmask_b32 v215, v213, v31, s[60:61]
  v_cmp_eq_u32 s[62:63], 0, v1
  v_cmp_eq_u32 s[64:65], 3, v2
VJOB:
  s_lshl_b32 s10, s99, 7
  s_add_u32 s10, s10, s80
  v_add_u32 v10, s10, v20
  s_waitcnt vmcnt(0)
  ds_read_b64_tr_b16 v[120:121], v212 offset:0
  ds_read_b64_tr_b16 v[122:123], v213 offset:0
  ds_read_b64_tr_b16 v[124:125], v214 offset:32
  ds_read_b64_tr_b16 v[126:127], v215 offset:32
  v_lshlrev_b32 v22, 16, v22
  s_waitcnt lgkmcnt(0)
  v_mfma_f32_16x16x32_bf16 v[40:43], v[120:123], v[128:131], 0
  v_mfma_f32_16x16x32_bf16 v[44:47], v[124:127], v[128:131], 0
  s_nop 7
  v_cndmask_b32 v44, v44, v22, s[64:65]
  s_mov_b64 exec, s[62:63]
  global_store_dwordx4 v10, v[40:43], s[100:101] sc0 sc1
  global_store_dwordx4 v10, v[44:47], s[100:101] offset:64 sc0 sc1
  s_mov_b64 exec, -1
  s_cmp_lg_u32 s82, 0
  s_cbranch_scc1 VNEXT
  s_mov_b32 s14, 64
  s_branch PRET
VNEXT:
  s_add_u32 s99, s99, 3
  s_cmp_gt_u32 s99, 25
  s_cbranch_scc1 VEND
  s_mov_b32 m0, s83
  s_mul_i32 s10, s99, 52
  buffer_load_dwordx4 v21, s[36:39], s10 offen lds
  s_add_u32 m0, s83, 1024
  s_add_u32 s10, s10, 21632
  s_mov_b32 exec_hi, 0xff
  buffer_load_dwordx4 v21, s[36:39], s10 offen lds
  s_mov_b32 exec_hi, -1
  s_lshl_b32 s10, s99, 1
  buffer_load_ushort v22, v3, s[44:47], s10 offen offset:52
  s_branch VJOB
VEND:
  s_add_u32 s95, s95, 4
  v_mov_b32 v10, 1
  v_and_b32 v11, 262144, v28
  s_waitcnt vmcnt(0) lgkmcnt(0)
  ds_add_u32 v11, v10 offset:42160
  s_mov_b32 s91, 0x80000
AB3:
  ds_read_b32 v10, v3 offset:42160
  s_sub_u32 s91, s91, 1
  s_cbranch_scc1 AB3_x
  s_waitcnt lgkmcnt(0)
  v_readfirstlane_b32 s90, v10
  s_cmp_lt_u32 s90, s95
  s_cbranch_scc1 AB3
AB3_x:
  s_mov_b32 s99, s5
  s_cmp_eq_u32 s5, 3
  s_cbranch_scc1 TEND
  s_branch TLOAD
T1_:
  v_lshrrev_b32 v10, 2, v1
  v_cmp_lt_u32 vcc, 7, v1
  v_cmp_gt_u32 s[74:75], 10, v1
  v_cmp_eq_u32 s[68:69], 12, v1
  v_cmp_ge_u32 s[84:85], v10, v2
  v_and_b32 v11, 1, v1
  v_mul_u32_u24 v11, 400, v11
  v_bfe_u32 v12, v1, 1, 1
  v_lshrrev_b32 v13, 1, v2
  v_and_b32 v15, 1, v2
  v_add_u32 v14, 1, v10
  v_mul_u32_u24 v14, v14, v10
  v_lshrrev_b32 v14, 1, v14
  v_add_lshl_u32 v16, v14, v2, 4
  v_lshl_add_u32 v16, v12, 3, v16
  v_add_u32 v16, v16, v11
  v_cndmask_b32 v32, v31, v16, s[84:85]
  v_lshl_add_u32 v14, v10, 2, v14
  v_add_u32 v14, 10, v14
  v_cndmask_b32 v12, v12, v15, vcc
  v_cndmask_b32 v17, v2, v13, vcc
  v_cndmask_b32 v18, 64, 32, vcc
  v_add_lshl_u32 v16, v14, v17, 4
  v_lshl_add_u32 v16, v12, 3, v16
  v_add_u32 v16, v16, v11
  s_and_b64 s[84:85], s[84:85], s[74:75]
  v_cndmask_b32 v33, v31, v16, s[74:75]
  v_add_u32 v16, v16, v18
  v_cndmask_b32 v34, v31, v16, s[84:85]
  v_bfe_u32 v10, v0, 2, 2
  v_and_b32 v11, 3, v0
  v_lshl_add_u32 v14, v2, 3, v10
  v_cmp_eq_u32 s[60:61], 3, v11
  v_add_u32 v13, 0, v14
  v_cmp_lt_u32 vcc, 25, v13
  v_lshlrev_b32 v13, 6, v13
  v_lshl_add_u32 v13, v11, 3, v13
  v_add_u32 v13, s83, v13
  v_cndmask_b32 v212, v13, v31, vcc
  v_cndmask_b32 v214, v212, v31, s[60:61]
  v_add_u32 v13, 4, v14
  v_cmp_lt_u32 vcc, 25, v13
  v_lshlrev_b32 v13, 6, v13
  v_lshl_add_u32 v13, v11, 3, v13
  v_add_u32 v13, s83, v13
  v_cndmask_b32 v213, v13, v31, vcc
  v_cndmask_b32 v215, v213, v31, s[60:61]
  s_waitcnt vmcnt(0)
  v_mfma_f32_16x16x32_bf16 v[60:63], v[112:115], v[112:115], 0
  ds_read_b64_tr_b16 v[120:121], v212 offset:0
  ds_read_b64_tr_b16 v[122:123], v213 offset:0
  ds_read_b64_tr_b16 v[124:125], v214 offset:32
  ds_read_b64_tr_b16 v[126:127], v215 offset:32
  s_mul_i32 s98, s99, 816
  s_add_u32 s98, s98, 95456
  s_lshl_b32 s10, s99, 6
  s_add_u32 s10, s10, 116672
  v_add_u32 v35, s98, v32
  v_add_u32 v36, s98, v33
  v_add_u32 v37, s98, v34
  v_lshl_add_u32 v12, v2, 3, s10
  v_cndmask_b32 v36, v36, v12, s[68:69]
  v_add_u32 v12, 32, v12
  v_cndmask_b32 v37, v37, v12, s[68:69]
  v_and_b32 v38, 262144, v28
  v_add_u32 v38, s98, v38
  s_waitcnt lgkmcnt(0)
  v_mfma_f32_16x16x32_bf16 v[64:67], v[120:123], v[120:123], 0
  v_mfma_f32_16x16x32_bf16 v[64:67], v[124:127], v[124:127], v[64:67]
  s_sub_u32 s10, s10, 816
  v_cmp_lt_u32 vcc, 50, v0
  v_lshl_add_u32 v24, v0, 4, s98
  v_lshl_add_u32 v12, v0, 4, s10
  v_cndmask_b32 v24, v24, v12, vcc
  s_nop 2
  v_max3_f32 v70, |v64|, |v65|, |v66|
  v_max_f32 v70, |v67|, v70
  v_or_b32 v70, 1, v70
  v_max3_f32 v18, |v60|, |v61|, |v62|
  v_max_f32 v18, |v63|, v18
  v_or_b32 v18, 1, v18
  v_lshlrev_b32 v22, 16, v22
  v_lshlrev_b32 v23, 16, v23
  v_max_f32 v22, |v22|, |v23|
  s_nop 1
  v_max_u32_dpp v70, v70, v70 row_shr:1 row_mask:0xf bank_mask:0xf
  v_max_u32_dpp v18, v18, v18 row_shr:1 row_mask:0xf bank_mask:0xf
  v_max_u32_dpp v22, v22, v22 row_shr:1 row_mask:0xf bank_mask:0xf
  v_max_u32_dpp v70, v70, v70 row_shr:2 row_mask:0xf bank_mask:0xf
  v_max_u32_dpp v18, v18, v18 row_shr:2 row_mask:0xf bank_mask:0xf
  v_max_u32_dpp v22, v22, v22 row_shr:2 row_mask:0xf bank_mask:0xf
  v_max_u32_dpp v70, v70, v70 row_shr:4 row_mask:0xf bank_mask:0xf
  v_max_u32_dpp v18, v18, v18 row_shr:4 row_mask:0xf bank_mask:0xf
  v_max_u32_dpp v22, v22, v22 row_shr:4 row_mask:0xf bank_mask:0xf
  v_max_u32_dpp v70, v70, v70 row_shr:8 row_mask:0xf bank_mask:0xf
  v_max_u32_dpp v18, v18, v18 row_shr:8 row_mask:0xf bank_mask:0xf
  v_max_u32_dpp v22, v22, v22 row_shr:8 row_mask:0xf bank_mask:0xf
  v_max_u32_dpp v70, v70, v70 row_bcast:15 row_mask:0xa bank_mask:0xf
  v_max_u32_dpp v18, v18, v18 row_bcast:15 row_mask:0xa bank_mask:0xf
  v_max_u32_dpp v22, v22, v22 row_bcast:15 row_mask:0xa bank_mask:0xf
  v_max_u32_dpp v70, v70, v70 row_bcast:31 row_mask:0xc bank_mask:0xf
  v_max_u32_dpp v18, v18, v18 row_bcast:31 row_mask:0xc bank_mask:0xf
  v_max_u32_dpp v22, v22, v22 row_bcast:31 row_mask:0xc bank_mask:0xf
  s_nop 0
  v_readlane_b32 s6, v18, 63
  s_lshr_b32 s6, s6, 23
  s_add_u32 s6, s6, 135
  s_lshr_b32 s6, s6, 1
  s_cmp_eq_u32 s72, 0
  s_cselect_b32 s72, s6, s72
  v_readlane_b32 s76, v22, 63
  s_cmp_lg_u32 s82, 0
  s_cbranch_scc1 TV
  s_branch PRET
T2:
  s_mov_b32 s91, 80
TVP:
  global_load_dword v12, v3, s[34:35] offset:64 sc1
  s_sub_u32 s91, s91, 1
  s_waitcnt vmcnt(0)
  s_cbranch_scc1 TBACK
  v_readfirstlane_b32 s90, v12
  s_cmp_ge_u32 s90, 26
  s_cbranch_scc1 TV
  s_sleep 3
  s_branch TVP
TV:
  s_add_u32 s60, s100, s80
  s_addc_u32 s61, s101, 0
  s_and_b32 s61, s61, 0xffff
  s_mov_b32 s62, 3328
  s_mov_b32 s63, 0x20000
  v_lshlrev_b32 v39, 2, v1
  v_lshl_add_u32 v39, v2, 10, v39
  buffer_load_dword v40, v39, s[60:63], 0 offen offset:0 sc1
  buffer_load_dword v41, v39, s[60:63], 0 offen offset:128 sc1
  buffer_load_dword v42, v39, s[60:63], 0 offen offset:256 sc1
  buffer_load_dword v43, v39, s[60:63], 0 offen offset:384 sc1
  buffer_load_dword v44, v39, s[60:63], 0 offen offset:512 sc1
  buffer_load_dword v45, v39, s[60:63], 0 offen offset:640 sc1
  buffer_load_dword v46, v39, s[60:63], 0 offen offset:768 sc1
  buffer_load_dword v47, v39, s[60:63], 0 offen offset:896 sc1
  buffer_load_dword v48, v39, s[60:63], 0 offen offset:64 sc1
  buffer_load_dword v49, v39, s[60:63], 0 offen offset:192 sc1
  buffer_load_dword v50, v39, s[60:63], 0 offen offset:320 sc1
  buffer_load_dword v51, v39, s[60:63], 0 offen offset:448 sc1
  buffer_load_dword v52, v39, s[60:63], 0 offen offset:576 sc1
  buffer_load_dword v53, v39, s[60:63], 0 offen offset:704 sc1
  buffer_load_dword v54, v39, s[60:63], 0 offen offset:832 sc1
  buffer_load_dword v55, v39, s[60:63], 0 offen offset:960 sc1
  s_lshr_b32 s76, s76, 23
  s_max_u32 s76, s76, 40
  s_min_u32 s76, s76, 215
  s_sub_i32 s73, 133, s70
  s_waitcnt vmcnt(0)
  v_max3_f32 v12, |v40|, |v41|, |v42|
  v_max3_f32 v12, |v43|, |v44|, v12
  v_max3_f32 v12, |v45|, |v46|, v12
  v_max_f32 v12, |v47|, v12
  v_max3_f32 v13, |v48|, |v49|, |v50|
  v_max3_f32 v13, |v51|, |v52|, v13
  v_max3_f32 v13, |v53|, |v54|, v13
  v_max_f32 v13, |v55|, v13
  v_cndmask_b32 v13, 0, v13, s[74:75]
  v_max_u32 v12, v12, v13
  s_nop 1
  v_max_u32_dpp v12, v12, v12 row_shr:1 row_mask:0xf bank_mask:0xf
  s_nop 1
  v_max_u32_dpp v12, v12, v12 row_shr:2 row_mask:0xf bank_mask:0xf
  s_nop 1
  v_max_u32_dpp v12, v12, v12 row_shr:4 row_mask:0xf bank_mask:0xf
  s_nop 1
  v_max_u32_dpp v12, v12, v12 row_shr:8 row_mask:0xf bank_mask:0xf
  s_nop 1
  v_max_u32_dpp v12, v12, v12 row_bcast:15 row_mask:0xa bank_mask:0xf
  s_nop 1
  v_max_u32_dpp v12, v12, v12 row_bcast:31 row_mask:0xc bank_mask:0xf
  s_nop 0
  v_readlane_b32 s6, v12, 63
  s_lshr_b32 s6, s6, 23
  s_max_u32 s6, s6, 40
  s_min_u32 s6, s6, 215
  s_sub_i32 s77, 261, s6
  s_sub_i32 s77, s77, s72
  s_add_i32 s77, s77, s73
  s_add_i32 s77, s77, s73
  s_sub_i32 s78, 262, s76
  s_sub_i32 s78, s78, s72
  s_add_i32 s78, s78, s73
  s_min_i32 s77, s77, s78
  s_sub_i32 s78, 155, s76
  s_min_i32 s77, s77, s78
  s_sub_i32 s79, s77, s73
  s_sub_i32 s78, s79, s73
  v_mov_b32 v10, s78
  v_mov_b32 v11, s79
  v_cndmask_b32 v11, v10, v11, s[68:69]
  v_mov_b32 v68, s72
  v_mov_b32 v71, s77
  v_ldexp_f32 v40, v40, v10
  v_ldexp_f32 v41, v41, v10
  v_ldexp_f32 v42, v42, v10
  v_ldexp_f32 v43, v43, v10
  v_ldexp_f32 v44, v44, v10
  v_ldexp_f32 v45, v45, v10
  v_ldexp_f32 v46, v46, v10
  v_ldexp_f32 v47, v47, v10
  v_ldexp_f32 v48, v48, v11
  v_ldexp_f32 v49, v49, v11
  v_ldexp_f32 v50, v50, v11
  v_ldexp_f32 v51, v51, v11
  v_ldexp_f32 v52, v52, v11
  v_ldexp_f32 v53, v53, v11
  v_ldexp_f32 v54, v54, v11
  v_ldexp_f32 v55, v55, v11
  v_cvt_pk_bf16_f32 v128, v40, v41
  v_cvt_pk_bf16_f32 v129, v42, v43
  v_cvt_pk_bf16_f32 v130, v44, v45
  v_cvt_pk_bf16_f32 v131, v46, v47
  v_cvt_pk_bf16_f32 v132, v48, v49
  v_cvt_pk_bf16_f32 v133, v50, v51
  v_cvt_pk_bf16_f32 v134, v52, v53
  v_cvt_pk_bf16_f32 v135, v54, v55
TJOB:
  v_mov_b32 v69, v70
  v_mov_b32 v11, v24
  v_mfma_f32_16x16x32_bf16 v[84:87], v[120:123], v[128:131], 0
  v_mfma_f32_16x16x32_bf16 v[88:91], v[120:123], v[132:135], 0
  v_mfma_f32_16x16x32_bf16 v[84:87], v[128:131], v[120:123], v[84:87]
  v_mfma_f32_16x16x32_bf16 v[92:95], v[124:127], v[132:135], 0
  v_mfma_f32_16x16x32_bf16 v[88:91], v[128:131], v[124:127], v[88:91]
  v_mfma_f32_16x16x32_bf16 v[92:95], v[132:135], v[124:127], v[92:95]
  ds_write_b128 v38, v[68:71] offset:800
  s_nop 4
  v_cvt_pk_f16_f32 v152, v84, v85
  v_cvt_pk_f16_f32 v153, v86, v87
  ds_write_b64 v35, v[152:153]
  v_cvt_pk_f16_f32 v154, v88, v89
  v_cvt_pk_f16_f32 v155, v90, v91
  ds_write_b64 v36, v[154:155]
  v_cvt_pk_f16_f32 v156, v92, v93
  v_cvt_pk_f16_f32 v157, v94, v95
  ds_write_b64 v37, v[156:157]
  s_cmp_lg_u32 s82, 0
  s_cbranch_scc1 TNEXT
  ds_read_b128 v[40:43], v11
  v_add_u32 v10, 974336, v11
  v_cmp_gt_u32 vcc, 55, v0
  s_mov_b32 s14, 8
  s_mov_b64 exec, vcc
  s_waitcnt lgkmcnt(0)
  global_store_dwordx4 v10, v[40:43], s[100:101] sc0 sc1
  s_mov_b64 exec, -1
  s_branch TBACK
TNEXT:
  s_add_u32 s99, s99, 3
  s_cmp_gt_u32 s99, 25
  s_cbranch_scc1 TEND
  s_mov_b32 m0, s83
  s_mul_i32 s10, s99, 52
  buffer_load_dwordx4 v21, s[36:39], s10 offen lds
  s_add_u32 m0, s83, 1024
  s_add_u32 s10, s10, 21632
  s_mov_b32 exec_hi, 0xff
  buffer_load_dwordx4 v21, s[36:39], s10 offen lds
  s_mov_b32 exec_hi, -1
  s_waitcnt vmcnt(0)
  ds_read_b64_tr_b16 v[120:121], v212 offset:0
  ds_read_b64_tr_b16 v[122:123], v213 offset:0
  ds_read_b64_tr_b16 v[124:125], v214 offset:32
  ds_read_b64_tr_b16 v[126:127], v215 offset:32
  s_mul_i32 s98, s99, 816
  s_add_u32 s98, s98, 95456
  s_lshl_b32 s10, s99, 6
  s_add_u32 s10, s10, 116672
  v_add_u32 v35, s98, v32
  v_add_u32 v36, s98, v33
  v_add_u32 v37, s98, v34
  v_lshl_add_u32 v12, v2, 3, s10
  v_cndmask_b32 v36, v36, v12, s[68:69]
  v_add_u32 v12, 32, v12
  v_cndmask_b32 v37, v37, v12, s[68:69]
  v_and_b32 v38, 262144, v28
  v_add_u32 v38, s98, v38
  s_waitcnt lgkmcnt(0)
  v_mfma_f32_16x16x32_bf16 v[64:67], v[120:123], v[120:123], 0
  v_mfma_f32_16x16x32_bf16 v[64:67], v[124:127], v[124:127], v[64:67]
  s_sub_u32 s10, s10, 816
  v_cmp_lt_u32 vcc, 50, v0
  v_lshl_add_u32 v24, v0, 4, s98
  v_lshl_add_u32 v12, v0, 4, s10
  v_cndmask_b32 v24, v24, v12, vcc
  s_nop 2
  v_max3_f32 v70, |v64|, |v65|, |v66|
  v_max_f32 v70, |v67|, v70
  v_or_b32 v70, 1, v70
  s_nop 1
  v_max_u32_dpp v70, v70, v70 row_shr:1 row_mask:0xf bank_mask:0xf
  s_nop 1
  v_max_u32_dpp v70, v70, v70 row_shr:2 row_mask:0xf bank_mask:0xf
  s_nop 1
  v_max_u32_dpp v70, v70, v70 row_shr:4 row_mask:0xf bank_mask:0xf
  s_nop 1
  v_max_u32_dpp v70, v70, v70 row_shr:8 row_mask:0xf bank_mask:0xf
  s_nop 1
  v_max_u32_dpp v70, v70, v70 row_bcast:15 row_mask:0xa bank_mask:0xf
  s_nop 1
  v_max_u32_dpp v70, v70, v70 row_bcast:31 row_mask:0xc bank_mask:0xf
  s_branch TJOB
TEND:
  s_add_u32 s95, s95, 4
  v_mov_b32 v10, 1
  v_and_b32 v11, 262144, v28
  s_waitcnt vmcnt(0) lgkmcnt(0)
  ds_add_u32 v11, v10 offset:42160
  s_mov_b32 s91, 0x80000
AB4:
  ds_read_b32 v10, v3 offset:42160
  s_sub_u32 s91, s91, 1
  s_cbranch_scc1 AB4_x
  s_waitcnt lgkmcnt(0)
  v_readfirstlane_b32 s90, v10
  s_cmp_lt_u32 s90, s95
  s_cbranch_scc1 AB4
AB4_x:
  s_mov_b32 s99, s5
  s_cmp_eq_u32 s5, 3
  s_cbranch_scc1 WEND
  s_branch WLOAD
FALLBACK:
  s_cmp_eq_u32 s14, 0
  s_cbranch_scc1 H5
  s_waitcnt vmcnt(0)
  v_readfirstlane_b32 s6, v94
  s_mov_b32 s14, 0
  s_cmp_lg_u32 s6, 25
  s_cbranch_scc1 H5
  s_mov_b64 exec, 1
  global_store_dword v92, v93, s[34:35] offset:124 sc0 sc1
  s_mov_b64 exec, -1
H5:
  s_cmp_eq_u32 s82, 0
  s_cselect_b32 s95, 0, s95
  s_mov_b32 s82, 1
  s_mov_b32 s99, s5
  s_waitcnt vmcnt(0) lgkmcnt(0)
  v_mov_b32 v0, v102
  v_mov_b32 v28, v96
  v_mov_b32 v3, 0
  v_mov_b32 v31, 262144
  v_and_b32 v1, 15, v0
  v_lshrrev_b32 v2, 4, v0
  s_add_u32 s80, s2, 1
  s_lshl_b32 s80, s80, 12
  s_add_u32 s80, s80, 1179648
  s_mul_i32 s83, s5, 1664
  s_add_u32 s83, s83, 74240
  v_lshrrev_b32 v21, 2, v0
  v_mul_u32_u24 v21, 1352, v21
  v_and_b32 v11, 3, v0
  v_lshl_add_u32 v21, v11, 4, v21
  s_add_u32 s95, s95, 4
  v_mov_b32 v10, 1
  v_and_b32 v11, 262144, v28
  s_waitcnt vmcnt(0) lgkmcnt(0)
  ds_add_u32 v11, v10 offset:42160
  s_mov_b32 s91, 0x80000
AB6:
  ds_read_b32 v10, v3 offset:42160
  s_sub_u32 s91, s91, 1
  s_cbranch_scc1 AB6_x
  s_waitcnt lgkmcnt(0)
  v_readfirstlane_b32 s90, v10
  s_cmp_lt_u32 s90, s95
  s_cbranch_scc1 AB6
AB6_x:
  s_cmp_eq_u32 s5, 3
  s_cbranch_scc1 VEND
  s_branch VLOAD
ACONT:
  v_mul_u32_u24 v12, 144, v0
  v_mov_b32 v186, 32000
  s_waitcnt vmcnt(0)
  v_lshlrev_b32 v13, 1, v160
  v_and_b32 v13, 16, v13
  v_lshl_or_b32 v160, v160, 5, v13
  v_lshlrev_b32 v13, 1, v161
  v_and_b32 v13, 16, v13
  v_lshl_or_b32 v161, v161, 5, v13
  v_lshlrev_b32 v13, 1, v162
  v_and_b32 v13, 16, v13
  v_lshl_or_b32 v162, v162, 5, v13
  v_lshlrev_b32 v13, 1, v163
  v_and_b32 v13, 16, v13
  v_lshl_or_b32 v163, v163, 5, v13
  v_lshlrev_b32 v13, 1, v164
  v_and_b32 v13, 16, v13
  v_lshl_or_b32 v164, v164, 5, v13
  v_lshlrev_b32 v13, 1, v165
  v_and_b32 v13, 16, v13
  v_lshl_or_b32 v165, v165, 5, v13
  v_lshlrev_b32 v13, 1, v166
  v_and_b32 v13, 16, v13
  v_lshl_or_b32 v166, v166, 5, v13
  v_lshlrev_b32 v13, 1, v167
  v_and_b32 v13, 16, v13
  v_lshl_or_b32 v167, v167, 5, v13
  v_lshlrev_b32 v13, 1, v168
  v_and_b32 v13, 16, v13
  v_lshl_or_b32 v168, v168, 5, v13
  v_lshlrev_b32 v13, 1, v169
  v_and_b32 v13, 16, v13
  v_lshl_or_b32 v169, v169, 5, v13
  v_lshlrev_b32 v13, 1, v170
  v_and_b32 v13, 16, v13
  v_lshl_or_b32 v170, v170, 5, v13
  v_lshlrev_b32 v13, 1, v171
  v_and_b32 v13, 16, v13
  v_lshl_or_b32 v171, v171, 5, v13
  v_lshlrev_b32 v13, 1, v172
  v_and_b32 v13, 16, v13
  v_lshl_or_b32 v172, v172, 5, v13
  v_lshlrev_b32 v13, 1, v173
  v_and_b32 v13, 16, v13
  v_lshl_or_b32 v173, v173, 5, v13
  v_lshlrev_b32 v13, 1, v174
  v_and_b32 v13, 16, v13
  v_lshl_or_b32 v174, v174, 5, v13
  v_lshlrev_b32 v13, 1, v175
  v_and_b32 v13, 16, v13
  v_lshl_or_b32 v175, v175, 5, v13
  v_lshlrev_b32 v13, 1, v176
  v_and_b32 v13, 16, v13
  v_lshl_or_b32 v176, v176, 5, v13
  v_lshlrev_b32 v13, 1, v177
  v_and_b32 v13, 16, v13
  v_lshl_or_b32 v177, v177, 5, v13
  v_lshlrev_b32 v13, 1, v178
  v_and_b32 v13, 16, v13
  v_lshl_or_b32 v178, v178, 5, v13
  v_lshlrev_b32 v13, 1, v179
  v_and_b32 v13, 16, v13
  v_lshl_or_b32 v179, v179, 5, v13
  v_lshlrev_b32 v13, 1, v180
  v_and_b32 v13, 16, v13
  v_lshl_or_b32 v180, v180, 5, v13
  v_lshlrev_b32 v13, 1, v181
  v_and_b32 v13, 16, v13
  v_lshl_or_b32 v181, v181, 5, v13
  v_lshlrev_b32 v13, 1, v182
  v_and_b32 v13, 16, v13
  v_lshl_or_b32 v182, v182, 5, v13
  v_lshlrev_b32 v13, 1, v183
  v_and_b32 v13, 16, v13
  v_lshl_or_b32 v183, v183, 5, v13
  v_lshlrev_b32 v13, 1, v184
  v_and_b32 v13, 16, v13
  v_lshl_or_b32 v184, v184, 5, v13
  v_lshlrev_b32 v13, 1, v185
  v_and_b32 v13, 16, v13
  v_lshl_or_b32 v185, v185, 5, v13
  v_lshl_or_b32 v216, v164, 16, v160
  v_lshl_or_b32 v217, v172, 16, v168
  v_lshl_or_b32 v218, v180, 16, v176
  v_mov_b32 v219, v184
  ds_write_b128 v12, v[216:219] offset:32768
  v_lshl_or_b32 v220, v165, 16, v161
  v_lshl_or_b32 v221, v173, 16, v169
  v_lshl_or_b32 v222, v181, 16, v177
  v_mov_b32 v223, v185
  ds_write_b128 v12, v[220:223] offset:32784
  v_lshl_or_b32 v224, v166, 16, v162
  v_lshl_or_b32 v225, v174, 16, v170
  v_lshl_or_b32 v226, v182, 16, v178
  v_mov_b32 v227, v184
  ds_write_b128 v12, v[224:227] offset:32800
  v_lshl_or_b32 v228, v167, 16, v163
  v_lshl_or_b32 v229, v175, 16, v171
  v_lshl_or_b32 v230, v183, 16, v179
  v_mov_b32 v231, v185
  ds_write_b128 v12, v[228:231] offset:32816
  s_waitcnt lgkmcnt(0)
  s_barrier
  v_lshl_or_b32 v232, v168, 16, v160
  v_lshl_or_b32 v233, v184, 16, v176
  v_lshl_or_b32 v234, v170, 16, v162
  v_lshl_or_b32 v235, v185, 16, v178
  ds_write_b128 v12, v[232:235] offset:32832
  v_lshl_or_b32 v236, v172, 16, v164
  v_lshl_or_b32 v237, v184, 16, v180
  v_lshl_or_b32 v238, v174, 16, v166
  v_lshl_or_b32 v239, v186, 16, v182
  ds_write_b128 v12, v[236:239] offset:32848
  v_lshl_or_b32 v240, v169, 16, v161
  v_lshl_or_b32 v241, v184, 16, v177
  v_lshl_or_b32 v242, v171, 16, v163
  v_lshl_or_b32 v243, v185, 16, v179
  ds_write_b128 v12, v[240:243] offset:32864
  v_lshl_or_b32 v244, v173, 16, v165
  v_lshl_or_b32 v245, v185, 16, v181
  v_lshl_or_b32 v246, v175, 16, v167
  v_lshl_or_b32 v247, v186, 16, v183
  ds_write_b128 v12, v[244:247] offset:32880
  s_branch PDONE
PRET:
  s_cmp_eq_u32 s14, 0
  s_cbranch_scc1 H7
  v_mov_b32 v92, s14
  v_mov_b32 v93, 1
  s_mov_b64 exec, 1
  s_waitcnt vmcnt(0)
  global_atomic_add v94, v92, v93, s[34:35] sc0 sc1
  s_mov_b64 exec, -1
H7:
PDONE:
  s_cmp_lg_u32 s82, 0
  s_cbranch_scc1 NOCONV
  v_lshlrev_b32 v10, 2, v2
  v_sub_u32 v10, v1, v10
  v_mov_b32 v12, 0xffff
  v_mov_b32 v13, 0xffff0000
  v_cmp_eq_u32 vcc, 0, v10
  v_cmp_eq_u32 s[64:65], 1, v10
  v_mov_b32 v104, 0
  v_cndmask_b32 v106, 0, v12, vcc
  v_cndmask_b32 v106, v106, v13, s[64:65]
  v_mov_b32 v108, 0
  v_cmp_eq_u32 vcc, 2, v10
  v_cmp_eq_u32 s[64:65], 3, v10
  v_mov_b32 v105, 0
  v_cndmask_b32 v107, 0, v12, vcc
  v_cndmask_b32 v107, v107, v13, s[64:65]
  v_mov_b32 v109, 0
  s_setprio 3
  s_lshl_b32 s9, s5, 10
  v_lshl_add_u32 v30, v0, 4, s9
  v_cmp_gt_u32 vcc, 3328, v30
  s_cmp_eq_u32 s5, 3
  s_cbranch_scc1 NOB0
  s_barrier
NOB0:
  v_cndmask_b32 v18, v31, v30, vcc
  ds_read_b128 v[216:219], v30 offset:0
  ds_read_b128 v[220:223], v30 offset:4096
  ds_read_b128 v[224:227], v30 offset:8192
  ds_read_b128 v[228:231], v30 offset:12288
  ds_read_b128 v[232:235], v30 offset:16384
  ds_read_b128 v[236:239], v30 offset:20480
  ds_read_b128 v[240:243], v30 offset:24576
  ds_read_b128 v[244:247], v18 offset:28672
  s_cmp_eq_u32 s14, 0
  s_cbranch_scc1 H8
  s_waitcnt vmcnt(0)
  v_readfirstlane_b32 s6, v94
  s_mov_b32 s14, 0
  s_cmp_lg_u32 s6, 25
  s_cbranch_scc1 H8
  s_mov_b64 exec, 1
  global_store_dword v92, v93, s[34:35] offset:124 sc0 sc1
  s_mov_b64 exec, -1
H8:
  s_waitcnt lgkmcnt(7)
  v_mfma_f32_16x16x32_bf16 v[56:59], v[216:219], v[216:219], 0
  s_waitcnt lgkmcnt(6)
  v_mfma_f32_16x16x32_bf16 v[56:59], v[220:223], v[220:223], v[56:59]
  s_waitcnt lgkmcnt(5)
  v_mfma_f32_16x16x32_bf16 v[56:59], v[224:227], v[224:227], v[56:59]
  s_waitcnt lgkmcnt(4)
  v_mfma_f32_16x16x32_bf16 v[56:59], v[228:231], v[228:231], v[56:59]
  s_waitcnt lgkmcnt(3)
  v_mfma_f32_16x16x32_bf16 v[56:59], v[232:235], v[232:235], v[56:59]
  s_waitcnt lgkmcnt(2)
  v_mfma_f32_16x16x32_bf16 v[56:59], v[236:239], v[236:239], v[56:59]
  s_waitcnt lgkmcnt(1)
  v_mfma_f32_16x16x32_bf16 v[56:59], v[240:243], v[240:243], v[56:59]
  s_waitcnt lgkmcnt(0)
  v_mfma_f32_16x16x32_bf16 v[56:59], v[244:247], v[244:247], v[56:59]
  s_nop 7
  v_max3_f32 v16, |v56|, |v57|, |v58|
  v_max_f32 v16, |v59|, v16
  v_or_b32 v16, 1, v16
  s_nop 1
  v_max_u32_dpp v16, v16, v16 row_shr:1 row_mask:0xf bank_mask:0xf
  s_nop 1
  v_max_u32_dpp v16, v16, v16 row_shr:2 row_mask:0xf bank_mask:0xf
  s_nop 1
  v_max_u32_dpp v16, v16, v16 row_shr:4 row_mask:0xf bank_mask:0xf
  s_nop 1
  v_max_u32_dpp v16, v16, v16 row_shr:8 row_mask:0xf bank_mask:0xf
  s_nop 1
  v_max_u32_dpp v16, v16, v16 row_bcast:15 row_mask:0xa bank_mask:0xf
  s_nop 1
  v_max_u32_dpp v16, v16, v16 row_bcast:31 row_mask:0xc bank_mask:0xf
  ds_write_b32 v28, v16 offset:41984
  v_add_u32 v30, 42208, v30
  v_add_u32 v29, 42208, v18
  s_mov_b32 s91, 0x80000
  s_branch SW9_f
SW9:
  s_setprio 0
  s_sleep 1
SW9_f:
  ds_read_b128 v[56:59], v3 offset:41984
  s_sub_u32 s91, s91, 1
  s_cbranch_scc1 SW9_x
  s_waitcnt lgkmcnt(0)
  v_min_u32 v60, v56, v57
  v_min3_u32 v60, v60, v58, v59
  s_nop 0
  v_readfirstlane_b32 s90, v60
  s_cmp_eq_u32 s90, 0
  s_cbranch_scc1 SW9
SW9_x:
  s_setprio 3
  v_max3_u32 v56, v56, v57, v58
  v_max_u32 v56, v56, v59
  s_nop 0
  v_readfirstlane_b32 s70, v56
  s_lshr_b32 s70, s70, 23
  s_add_u32 s70, s70, 127
  s_lshr_b32 s70, s70, 1
  s_cmp_eq_u32 s14, 0
  s_cbranch_scc1 H10
  s_waitcnt vmcnt(0)
  v_readfirstlane_b32 s6, v94
  s_mov_b32 s14, 0
  s_cmp_lg_u32 s6, 25
  s_cbranch_scc1 H10
  s_mov_b64 exec, 1
  global_store_dword v92, v93, s[34:35] offset:124 sc0 sc1
  s_mov_b64 exec, -1
H10:
  s_sub_i32 s6, 260, s70
  s_lshl_b32 s6, s6, 7
  s_mul_i32 s6, s6, 0x10001
  v_and_b32 v106, s6, v106
  v_and_b32 v107, s6, v107
  s_waitcnt lgkmcnt(0)
  s_nop 0
  v_mfma_f32_16x16x32_bf16 v[40:43], v[106:109], v[216:219], 0
  v_mfma_f32_16x16x32_bf16 v[44:47], v[104:107], v[216:219], 0
  v_mfma_f32_16x16x32_bf16 v[48:51], v[106:109], v[220:223], 0
  v_mfma_f32_16x16x32_bf16 v[52:55], v[104:107], v[220:223], 0
  s_nop 3
  v_mfma_f32_16x16x32_bf16 v[56:59], v[106:109], v[224:227], 0
  v_cvt_pk_f16_f32 v216, v40, v41
  v_cvt_pk_f16_f32 v217, v42, v43
  v_mfma_f32_16x16x32_bf16 v[60:63], v[104:107], v[224:227], 0
  v_cvt_pk_f16_f32 v218, v44, v45
  v_cvt_pk_f16_f32 v219, v46, v47
  ds_write_b128 v30, v[216:219] offset:0
  v_mfma_f32_16x16x32_bf16 v[40:43], v[106:109], v[228:231], 0
  v_cvt_pk_f16_f32 v220, v48, v49
  v_cvt_pk_f16_f32 v221, v50, v51
  v_mfma_f32_16x16x32_bf16 v[44:47], v[104:107], v[228:231], 0
  v_cvt_pk_f16_f32 v222, v52, v53
  v_cvt_pk_f16_f32 v223, v54, v55
  ds_write_b128 v30, v[220:223] offset:4096
  v_mfma_f32_16x16x32_bf16 v[48:51], v[106:109], v[232:235], 0
  v_cvt_pk_f16_f32 v224, v56, v57
  v_cvt_pk_f16_f32 v225, v58, v59
  v_mfma_f32_16x16x32_bf16 v[52:55], v[104:107], v[232:235], 0
  v_cvt_pk_f16_f32 v226, v60, v61
  v_cvt_pk_f16_f32 v227, v62, v63
  ds_write_b128 v30, v[224:227] offset:8192
  v_mfma_f32_16x16x32_bf16 v[56:59], v[106:109], v[236:239], 0
  v_cvt_pk_f16_f32 v228, v40, v41
  v_cvt_pk_f16_f32 v229, v42, v43
  v_mfma_f32_16x16x32_bf16 v[60:63], v[104:107], v[236:239], 0
  v_cvt_pk_f16_f32 v230, v44, v45
  v_cvt_pk_f16_f32 v231, v46, v47
  ds_write_b128 v30, v[228:231] offset:12288
  v_mfma_f32_16x16x32_bf16 v[40:43], v[106:109], v[240:243], 0
  v_cvt_pk_f16_f32 v232, v48, v49
  v_cvt_pk_f16_f32 v233, v50, v51
  v_mfma_f32_16x16x32_bf16 v[44:47], v[104:107], v[240:243], 0
  v_cvt_pk_f16_f32 v234, v52, v53
  v_cvt_pk_f16_f32 v235, v54, v55
  ds_write_b128 v30, v[232:235] offset:16384
  v_mfma_f32_16x16x32_bf16 v[48:51], v[106:109], v[244:247], 0
  v_cvt_pk_f16_f32 v236, v56, v57
  v_cvt_pk_f16_f32 v237, v58, v59
  v_mfma_f32_16x16x32_bf16 v[52:55], v[104:107], v[244:247], 0
  v_cvt_pk_f16_f32 v238, v60, v61
  v_cvt_pk_f16_f32 v239, v62, v63
  ds_write_b128 v30, v[236:239] offset:20480
  s_nop 1
  v_cvt_pk_f16_f32 v240, v40, v41
  v_cvt_pk_f16_f32 v241, v42, v43
  s_nop 1
  v_cvt_pk_f16_f32 v242, v44, v45
  v_cvt_pk_f16_f32 v243, v46, v47
  ds_write_b128 v30, v[240:243] offset:24576
  s_nop 1
  v_cvt_pk_f16_f32 v244, v48, v49
  v_cvt_pk_f16_f32 v245, v50, v51
  s_nop 1
  v_cvt_pk_f16_f32 v246, v52, v53
  v_cvt_pk_f16_f32 v247, v54, v55
  ds_write_b128 v29, v[244:247] offset:28672
  v_mov_b32 v10, 0x74007400
  v_lshlrev_b32 v11, 2, v0
  v_and_b32 v11, 28, v11
  v_add_u32 v11, 74208, v11
  ds_write_b32 v11, v10
  ds_write_b32 v28, v0 offset:42064
  s_sub_u32 s6, s81, 54
  s_cmp_lt_u32 s6, 26
  s_cbranch_scc1 T2
TBACK:
  s_mov_b32 s71, 0
  s_mov_b32 s72, 0
NOCONV:
  s_sub_i32 s75, 133, s70
  s_lshl_b32 s9, s5, 10
  v_lshl_add_u32 v98, v0, 4, s9
  v_mov_b32 v96, v28
  v_mov_b32 v97, 0
  v_mov_b32 v102, v0
  v_and_b32 v14, 31, v0
  v_cmp_eq_u32 vcc, 28, v14
  v_cmp_gt_u32 s[86:87], 25, v14
  v_cmp_lt_u32 s[84:85], 31, v0
  v_cndmask_b32 v14, v14, 25, vcc
  s_or_b64 s[86:87], s[86:87], vcc
  v_lshrrev_b32 v15, 5, v0
  v_lshlrev_b32 v25, 1, v14
  global_load_ushort v103, v25, s[22:23]
  global_load_ushort v95, v3, s[30:31]
  v_lshlrev_b32 v99, 6, v14
  v_add_u32 v99, 116672, v99
  v_cndmask_b32 v99, v31, v99, s[86:87]
  v_mul_u32_u24 v7, 816, v14
  v_mul_u32_u24 v13, 400, v15
  v_add_u32 v7, 74240, v7
  v_cndmask_b32 v4, v31, v7, s[86:87]
  v_add_u32 v7, v4, v13
  v_mov_b32 v13, 0x05040100
  v_mov_b32 v14, 0x07060302
  v_cndmask_b32 v100, v13, v14, s[84:85]
  v_cndmask_b32 v101, v14, v13, s[84:85]
  s_andn2_b64 s[86:87], s[86:87], s[84:85]
  s_add_u32 s44, s100, 1048576
  s_addc_u32 s45, s101, 0
  s_and_b32 s45, s45, 0xffff
  s_mov_b32 s46, 44096
  s_mov_b32 s74, 0x38003800
  v_and_b32 v13, 1, v2
  s_lshl_b32 s8, s5, 4
  v_add_u32 v13, s8, v13
  v_mul_u32_u24 v13, 144, v13
  v_add_u32 v13, 32768, v13
  v_bfe_u32 v10, v0, 2, 2
  v_and_b32 v1, 3, v0
  v_lshl_add_u32 v2, v10, 4, v13
  v_lshl_add_u32 v3, v10, 3, v13
  v_lshl_add_u32 v3, v15, 5, v3
  v_lshlrev_b32 v1, 3, v1
  s_mul_i32 s8, s5, 2304
  s_add_u32 s8, s8, 32768
  v_lshl_add_u32 v5, v0, 2, s8
  v_mov_b32 v0, v7
  s_cmp_lg_u32 s5, 3
  s_cbranch_scc1 PI11
  global_load_dwordx2 v[18:19], v97, s[34:35] offset:128 sc1
PI11:
  s_mov_b32 s73, s82
  s_setprio 1
  s_mov_b32 s91, 0x80000
  s_branch SW12_f
SW12:
  s_setprio 0
  s_sleep 1
SW12_f:
  ds_read_b128 v[40:43], v97 offset:42064
  ds_read_b128 v[44:47], v97 offset:42080
  s_sub_u32 s91, s91, 1
  s_cbranch_scc1 SW12_x
  s_waitcnt lgkmcnt(0)
  v_min_u32 v48, v40, v41
  v_min3_u32 v48, v48, v42, v43
  v_min3_u32 v48, v48, v44, v45
  v_min3_u32 v48, v48, v46, v47
  s_nop 0
  v_readfirstlane_b32 s90, v48
  s_cmp_eq_u32 s90, 0
  s_cbranch_scc1 SW12
SW12_x:
  s_setprio 1
  ds_read_b96 v[8:10], v2 offset:0
  ds_read_b64 v[6:7], v3 offset:64
  s_lshl_b32 s6, s82, 2
  s_add_u32 s6, s6, s5
  s_cmp_lg_u32 s6, 3
  s_cbranch_scc1 Q_x
  s_mov_b32 s91, 80
  v_mov_b32 v17, 2
Q_p:
  s_waitcnt vmcnt(0)
  v_readfirstlane_b32 s6, v18
  s_cmp_lg_u32 s6, 0
  s_cbranch_scc1 Q_o
  s_sub_u32 s91, s91, 1
  s_cbranch_scc1 Q_x
  s_sleep 8
  global_load_dwordx2 v[18:19], v97, s[34:35] offset:128 sc1
  s_branch Q_p
Q_o:
  v_mov_b32 v17, 1
  v_lshlrev_b32 v16, 4, v102
  s_mov_b32 s11, 0
Q_l:
  s_add_u32 m0, s11, 74240
  s_cmp_lt_u32 s11, 20480
  s_cselect_b32 exec_hi, -1, 16383
  buffer_load_dwordx4 v16, s[44:47], s11 offen sc1 lds
  s_add_u32 s11, s11, 1024
  s_cmp_lt_u32 s11, 21216
  s_cbranch_scc1 Q_l
  s_mov_b32 exec_hi, -1
Q_x:
  s_waitcnt lgkmcnt(0)
  v_xor_b32_sdwa v11, v1, v8 dst_sel:DWORD dst_unused:UNUSED_PAD src0_sel:DWORD src1_sel:WORD_0
  ds_read_b64_tr_b16 v[20:21], v11 offset:42208
  v_xor_b32_sdwa v11, v1, v8 dst_sel:DWORD dst_unused:UNUSED_PAD src0_sel:DWORD src1_sel:WORD_1
  ds_read_b64_tr_b16 v[22:23], v11 offset:42208
  v_xor_b32_sdwa v11, v1, v9 dst_sel:DWORD dst_unused:UNUSED_PAD src0_sel:DWORD src1_sel:WORD_0
  ds_read_b64_tr_b16 v[24:25], v11 offset:42208
  v_xor_b32_sdwa v11, v1, v9 dst_sel:DWORD dst_unused:UNUSED_PAD src0_sel:DWORD src1_sel:WORD_1
  ds_read_b64_tr_b16 v[26:27], v11 offset:42208
  v_xor_b32_sdwa v11, v1, v10 dst_sel:DWORD dst_unused:UNUSED_PAD src0_sel:DWORD src1_sel:WORD_0
  ds_read_b64_tr_b16 v[28:29], v11 offset:42208
  v_xor_b32_sdwa v11, v1, v10 dst_sel:DWORD dst_unused:UNUSED_PAD src0_sel:DWORD src1_sel:WORD_1
  ds_read_b64_tr_b16 v[30:31], v11 offset:42208
  v_xor_b32_sdwa v11, v1, v7 dst_sel:DWORD dst_unused:UNUSED_PAD src0_sel:DWORD src1_sel:WORD_1
  ds_read_b64_tr_b16 v[38:39], v11 offset:42208
  v_xor_b32_sdwa v11, v1, v6 dst_sel:DWORD dst_unused:UNUSED_PAD src0_sel:DWORD src1_sel:WORD_0
  ds_read_b64_tr_b16 v[32:33], v11 offset:42208
  v_xor_b32_sdwa v11, v1, v6 dst_sel:DWORD dst_unused:UNUSED_PAD src0_sel:DWORD src1_sel:WORD_1
  ds_read_b64_tr_b16 v[34:35], v11 offset:42208
  v_xor_b32_sdwa v11, v1, v7 dst_sel:DWORD dst_unused:UNUSED_PAD src0_sel:DWORD src1_sel:WORD_0
  ds_read_b64_tr_b16 v[36:37], v11 offset:42208
  s_cmp_eq_u32 s14, 0
  s_cbranch_scc1 H13
  v_mov_b32 v92, s14
  v_mov_b32 v93, 1
  s_mov_b64 exec, 1
  s_waitcnt vmcnt(0)
  global_atomic_add v94, v92, v93, s[34:35] sc0 sc1
  s_mov_b64 exec, -1
H13:
  s_cmp_eq_u32 s14, 0
  s_cbranch_scc1 H14
  s_waitcnt vmcnt(0)
  v_readfirstlane_b32 s6, v94
  s_mov_b32 s14, 0
  s_cmp_lg_u32 s6, 25
  s_cbranch_scc1 H14
  s_mov_b64 exec, 1
  global_store_dword v92, v93, s[34:35] offset:124 sc0 sc1
  s_mov_b64 exec, -1
H14:
  s_cmp_lg_u32 s82, 0
  s_cbranch_scc1 Q_e
  s_cmp_lg_u32 s5, 3
  s_cbranch_scc1 Q_w
  v_lshlrev_b32 v16, 2, v102
  v_and_b32 v16, 12, v16
  s_waitcnt vmcnt(0)
  ds_write_b32 v16, v17 offset:42096
Q_w:
  s_mov_b32 s91, 0x80000
  s_branch SW15_f
SW15:
  s_setprio 0
  s_sleep 1
SW15_f:
  ds_read_b128 v[12:15], v97 offset:42096
  s_sub_u32 s91, s91, 1
  s_cbranch_scc1 SW15_x
  s_waitcnt lgkmcnt(0)
  v_min_u32 v16, v12, v13
  v_min3_u32 v16, v16, v14, v15
  s_nop 0
  v_readfirstlane_b32 s90, v16
  s_cmp_eq_u32 s90, 0
  s_cbranch_scc1 SW15
SW15_x:
  s_setprio 1
  s_cmp_eq_u32 s90, 2
  s_cbranch_scc1 FALLBACK
Q_e:
  s_cmp_lg_u32 s5, 3
  s_cbranch_scc1 PI16
  global_load_dwordx2 v[18:19], v97, s[34:35] offset:128 sc1
PI16:
  ds_read_b64 v[12:13], v4 offset:800
  ds_read_b128 v[40:43], v0 offset:0
  ds_read_b128 v[44:47], v0 offset:32
  ds_read_b128 v[48:51], v0 offset:80
  ds_read_b128 v[52:55], v0 offset:144
  ds_read_b128 v[56:59], v0 offset:224
  ds_read_b128 v[60:63], v0 offset:320
  ds_read_b128 v[64:67], v0 offset:384
  ds_read_b128 v[112:115], v0 offset:16
  ds_read_b128 v[116:119], v0 offset:48
  ds_read_b128 v[120:123], v0 offset:64
  ds_read_b128 v[124:127], v0 offset:112
  ds_read_b128 v[128:131], v0 offset:160
  ds_read_b128 v[132:135], v0 offset:176
  ds_read_b128 v[136:139], v0 offset:192
  ds_read_b128 v[140:143], v0 offset:208
  ds_read_b128 v[144:147], v0 offset:256
  ds_read_b128 v[148:151], v0 offset:304
  ds_read_b128 v[152:155], v0 offset:336
  ds_read_b128 v[156:159], v0 offset:352
  ds_read_b128 v[160:163], v0 offset:368
  s_waitcnt lgkmcnt(15)
  s_nop 1
  v_max_u32_dpp v13, v13, v13 row_shr:1 row_mask:0xf bank_mask:0xf
  s_nop 1
  v_max_u32_dpp v13, v13, v13 row_shr:2 row_mask:0xf bank_mask:0xf
  s_nop 1
  v_max_u32_dpp v13, v13, v13 row_shr:4 row_mask:0xf bank_mask:0xf
  s_nop 1
  v_max_u32_dpp v13, v13, v13 row_shr:8 row_mask:0xf bank_mask:0xf
  s_nop 1
  v_max_u32_dpp v13, v13, v13 row_bcast:15 row_mask:0xa bank_mask:0xf
  s_nop 1
  v_max_u32_dpp v13, v13, v13 row_bcast:31 row_mask:0xc bank_mask:0xf
  v_readfirstlane_b32 s7, v12
  v_readlane_b32 s6, v13, 63
  s_lshr_b32 s6, s6, 23
  s_add_u32 s6, s6, 127
  s_lshr_b32 s71, s6, 1
  s_sub_u32 s10, s7, s71
  s_cmp_gt_u32 s10, 12
  s_cbranch_scc1 FALLBACK
  s_mov_b32 s71, s7
  s_cmp_lg_u32 s73, 0
  s_cbranch_scc1 G17_x
  s_cmp_lg_u32 s5, 3
  s_cbranch_scc1 G17_w
  s_mov_b32 s91, 80
  s_mov_b32 s90, 2
G17_p:
  s_waitcnt vmcnt(0)
  v_readfirstlane_b32 s6, v19
  v_readfirstlane_b32 s7, v19
  s_cmp_lg_u32 s6, 0
  s_cbranch_scc1 G17_o
  s_sub_u32 s91, s91, 1
  s_cbranch_scc1 G17_d
  s_sleep 8
  global_load_dwordx2 v[18:19], v97, s[34:35] offset:128 sc1
  s_branch G17_p
G17_o:
  s_cmp_lg_u32 s7, 0
  s_cselect_b32 s90, 1, 1
G17_d:
  v_lshlrev_b32 v18, 2, v102
  v_and_b32 v18, 12, v18
  v_mov_b32 v19, s90
  ds_write_b32 v18, v19 offset:42176
  s_branch G17_c
G17_w:
  s_mov_b32 s91, 0x80000
  s_branch SW18_f
SW18:
  s_setprio 0
  s_sleep 1
SW18_f:
  ds_read_b128 v[80:83], v97 offset:42176
  s_sub_u32 s91, s91, 1
  s_cbranch_scc1 SW18_x
  s_waitcnt lgkmcnt(0)
  v_min_u32 v84, v80, v81
  v_min3_u32 v84, v84, v82, v83
  s_nop 0
  v_readfirstlane_b32 s90, v84
  s_cmp_eq_u32 s90, 0
  s_cbranch_scc1 SW18
SW18_x:
  s_setprio 1
G17_c:
  s_cmp_eq_u32 s90, 2
  s_cbranch_scc1 FALLBACK
  s_add_u32 s6, s9, 95456
  v_cmp_gt_u32 vcc, 2400, v98
  s_add_u32 m0, s6, 0
  s_mov_b32 s11, 21216
  buffer_load_dwordx4 v98, s[44:47], s11 offen sc1 lds
  s_add_u32 m0, s6, 4096
  s_mov_b32 s11, 25312
  buffer_load_dwordx4 v98, s[44:47], s11 offen sc1 lds
  s_add_u32 m0, s6, 8192
  s_mov_b32 s11, 29408
  buffer_load_dwordx4 v98, s[44:47], s11 offen sc1 lds
  s_add_u32 m0, s6, 12288
  s_mov_b32 s11, 33504
  buffer_load_dwordx4 v98, s[44:47], s11 offen sc1 lds
  s_add_u32 m0, s6, 16384
  s_mov_b32 s11, 37600
  buffer_load_dwordx4 v98, s[44:47], s11 offen sc1 lds
  s_and_saveexec_b64 s[66:67], vcc
  s_cbranch_execz G17_f
  s_add_u32 m0, s6, 20480
  s_mov_b32 s11, 41696
  buffer_load_dwordx4 v98, s[44:47], s11 offen sc1 lds
G17_f:
  s_mov_b64 exec, -1
G17_x:
  s_waitcnt lgkmcnt(13)
  v_perm_b32 v164, v43, v40, v100
  v_pk_mul_f16 v164, v164, s74
  v_perm_b32 v165, v47, v44, v100
  v_pk_mul_f16 v165, v165, s74
  v_mov_b32 v166, v45
  v_mov_b32 v176, v41
  v_cndmask_b32 v16, v40, v44, s[84:85]
  v_cndmask_b32 v17, v43, v47, s[84:85]
  v_perm_b32 v167, v17, v16, v101
  v_perm_b32 v168, v51, v48, v100
  v_pk_mul_f16 v168, v168, s74
  v_perm_b32 v169, v55, v52, v100
  v_pk_mul_f16 v169, v169, s74
  v_mov_b32 v170, v53
  v_mov_b32 v177, v49
  v_cndmask_b32 v16, v48, v52, s[84:85]
  v_cndmask_b32 v17, v51, v55, s[84:85]
  v_perm_b32 v171, v17, v16, v101
  v_perm_b32 v172, v59, v56, v100
  v_pk_mul_f16 v172, v172, s74
  v_perm_b32 v173, v63, v60, v100
  v_pk_mul_f16 v173, v173, s74
  v_mov_b32 v174, v61
  v_mov_b32 v178, v57
  v_cndmask_b32 v16, v56, v60, s[84:85]
  v_cndmask_b32 v17, v59, v63, s[84:85]
  v_perm_b32 v175, v17, v16, v101
  v_pk_mul_f16 v179, v64, s74
  s_cmp_lg_u32 s73, 0
  s_cbranch_scc1 G19
  s_waitcnt vmcnt(0)
  ds_write_b32 v96, v102 offset:42000
  s_mov_b32 s91, 0x80000
  s_branch SW20_f
SW20:
  s_setprio 0
  s_sleep 1
SW20_f:
  ds_read_b128 v[12:15], v97 offset:42000
  s_sub_u32 s91, s91, 1
  s_cbranch_scc1 SW20_x
  s_waitcnt lgkmcnt(0)
  v_min_u32 v16, v12, v13
  v_min3_u32 v16, v16, v14, v15
  s_nop 0
  v_readfirstlane_b32 s90, v16
  s_cmp_eq_u32 s90, 0
  s_cbranch_scc1 SW20
SW20_x:
  s_setprio 1
G19:
  ds_read_b128 v[12:15], v4 offset:22016
  ds_read_b128 v[72:75], v99 offset:0
  ds_read_b128 v[76:79], v99 offset:16
  ds_read_b128 v[80:83], v99 offset:32
  ds_read_b128 v[84:87], v99 offset:48
  ds_read_b128 v[40:43], v0 offset:21216
  ds_read_b128 v[44:47], v0 offset:21248
  ds_read_b128 v[48:51], v0 offset:21296
  ds_read_b128 v[52:55], v0 offset:21360
  ds_read_b128 v[56:59], v0 offset:21440
  ds_read_b128 v[60:63], v0 offset:21536
  ds_read_b128 v[64:67], v0 offset:21600
  ds_read_b128 v[104:107], v0 offset:96
  ds_read_b128 v[108:111], v0 offset:21312
  ds_read_b128 v[180:183], v0 offset:21232
  ds_read_b128 v[184:187], v0 offset:21264
  ds_read_b128 v[188:191], v0 offset:21280
  ds_read_b128 v[192:195], v0 offset:21328
  ds_read_b128 v[196:199], v0 offset:21376
  ds_read_b128 v[200:203], v0 offset:21392
  ds_read_b128 v[204:207], v0 offset:21408
  ds_read_b128 v[208:211], v0 offset:21424
  ds_read_b128 v[212:215], v0 offset:21472
  ds_read_b128 v[216:219], v0 offset:21520
  ds_read_b128 v[220:223], v0 offset:21552
  ds_read_b128 v[224:227], v0 offset:21568
  ds_read_b128 v[228:231], v0 offset:21584
  s_waitcnt lgkmcnt(15)
  s_nop 1
  v_max_u32_dpp v13, v13, v13 row_shr:1 row_mask:0xf bank_mask:0xf
  s_nop 1
  v_max_u32_dpp v13, v13, v13 row_shr:2 row_mask:0xf bank_mask:0xf
  s_nop 1
  v_max_u32_dpp v13, v13, v13 row_shr:4 row_mask:0xf bank_mask:0xf
  s_nop 1
  v_max_u32_dpp v13, v13, v13 row_shr:8 row_mask:0xf bank_mask:0xf
  s_nop 1
  v_max_u32_dpp v13, v13, v13 row_bcast:15 row_mask:0xa bank_mask:0xf
  s_nop 1
  v_max_u32_dpp v13, v13, v13 row_bcast:31 row_mask:0xc bank_mask:0xf
  v_readfirstlane_b32 s7, v12
  v_readlane_b32 s6, v13, 63
  s_lshr_b32 s6, s6, 23
  s_add_u32 s6, s6, 127
  s_lshr_b32 s72, s6, 1
  s_sub_u32 s10, s7, s72
  s_cmp_gt_u32 s10, 12
  s_cbranch_scc1 FALLBACK
  s_mov_b32 s72, s7
  v_readfirstlane_b32 s77, v15
  s_waitcnt vmcnt(0)
  v_readfirstlane_b32 s83, v95
  v_lshlrev_b32 v19, 16, v103
  s_sub_i32 s80, s77, 14
  v_ldexp_f32 v19, v19, s80
  v_cndmask_b32 v19, 0, v19, s[86:87]
  v_cvt_pk_f16_f32 v19, v19, v19
  s_sub_i32 s76, 140, s71
  s_add_i32 s81, s77, s76
  s_add_i32 s81, s81, s75
  s_add_i32 s81, s81, s75
  s_sub_i32 s81, 0, s81
  s_lshl_b32 s83, s83, 16
  s_mov_b32 s8, 0
  s_movk_i32 s9, 576
  s_waitcnt vmcnt(0)
  v_perm_b32 v248, v73, v72, v100
  v_perm_b32 v249, v75, v74, v100
  v_perm_b32 v250, v77, v76, v100
  v_perm_b32 v251, v79, v78, v100
  v_perm_b32 v252, v81, v80, v100
  v_perm_b32 v253, v83, v82, v100
  v_mov_b32 v254, 0
  v_perm_b32 v255, v19, v84, v100
  v_perm_b32 v232, v43, v40, v100
  v_pk_mul_f16 v232, v232, s74
  v_perm_b32 v233, v47, v44, v100
  v_pk_mul_f16 v233, v233, s74
  v_mov_b32 v234, v45
  v_mov_b32 v244, v41
  v_cndmask_b32 v16, v40, v44, s[84:85]
  v_cndmask_b32 v17, v43, v47, s[84:85]
  v_perm_b32 v235, v17, v16, v101
  v_perm_b32 v236, v51, v48, v100
  v_pk_mul_f16 v236, v236, s74
  v_perm_b32 v237, v55, v52, v100
  v_pk_mul_f16 v237, v237, s74
  v_mov_b32 v238, v53
  v_mov_b32 v245, v49
  v_cndmask_b32 v16, v48, v52, s[84:85]
  v_cndmask_b32 v17, v51, v55, s[84:85]
  v_perm_b32 v239, v17, v16, v101
  v_perm_b32 v240, v59, v56, v100
  v_pk_mul_f16 v240, v240, s74
  v_perm_b32 v241, v63, v60, v100
  v_pk_mul_f16 v241, v241, s74
  v_mov_b32 v242, v61
  v_mov_b32 v246, v57
  v_cndmask_b32 v16, v56, v60, s[84:85]
  v_cndmask_b32 v17, v59, v63, s[84:85]
  v_perm_b32 v243, v17, v16, v101
  v_pk_mul_f16 v247, v64, s74
  v_pk_mul_f16 v12, v34, v20 op_sel:[0,0] op_sel_hi:[0,1]
  v_pk_mul_f16 v13, v34, v21 op_sel:[0,0] op_sel_hi:[0,1]
  v_pk_mul_f16 v14, v34, v20 op_sel:[1,0] op_sel_hi:[1,1]
  v_pk_mul_f16 v15, v34, v21 op_sel:[1,0] op_sel_hi:[1,1]
  v_pk_mul_f16 v16, v35, v20 op_sel:[0,0] op_sel_hi:[0,1]
  v_pk_mul_f16 v17, v35, v21 op_sel:[0,0] op_sel_hi:[0,1]
  s_waitcnt lgkmcnt(0)
  s_setprio 1
  .p2align 3
CLOOP:
  v_mfma_f32_32x32x16_f16 v[40:55], v[116:119], v[12:15], 0
  v_pk_mul_f16 v18, v35, v20 op_sel:[1,0] op_sel_hi:[1,1]
  v_pk_mul_f16 v19, v35, v21 op_sel:[1,0] op_sel_hi:[1,1]
  ds_read_b96 v[8:10], v2 offset:288
  v_mfma_f32_32x32x16_f16 v[56:71], v[184:187], v[12:15], 0
  v_pk_mul_f16 v12, v33, v20 op_sel:[0,0] op_sel_hi:[0,1]
  v_pk_mul_f16 v13, v33, v21 op_sel:[0,0] op_sel_hi:[0,1]
  s_waitcnt lgkmcnt(4)
  s_nop 0
  v_mfma_f32_32x32x16_f16 v[40:55], v[104:107], v[16:19], v[40:55]
  v_pk_mul_f16 v14, v33, v20 op_sel:[1,0] op_sel_hi:[1,1]
  v_pk_mul_f16 v15, v33, v21 op_sel:[1,0] op_sel_hi:[1,1]
  ds_read_b128 v[104:107], v0 offset:128
  v_mfma_f32_32x32x16_f16 v[56:71], v[108:111], v[16:19], v[56:71]
  v_pk_mul_f16 v16, v34, v22 op_sel:[0,0] op_sel_hi:[0,1]
  v_pk_mul_f16 v17, v34, v23 op_sel:[0,0] op_sel_hi:[0,1]
  ds_read_b128 v[108:111], v0 offset:21344
  v_mfma_f32_32x32x16_f16 v[40:55], v[112:115], v[12:15], v[40:55]
  v_pk_mul_f16 v18, v34, v22 op_sel:[1,0] op_sel_hi:[1,1]
  v_pk_mul_f16 v19, v34, v23 op_sel:[1,0] op_sel_hi:[1,1]
  ds_read_b64 v[6:7], v3 offset:352
  v_mfma_f32_32x32x16_f16 v[56:71], v[180:183], v[12:15], v[56:71]
  v_pk_mul_f16 v12, v35, v22 op_sel:[0,0] op_sel_hi:[0,1]
  v_pk_mul_f16 v13, v35, v23 op_sel:[0,0] op_sel_hi:[0,1]
  v_mul_f32_e64 v4, v72, v88
  v_mfma_f32_32x32x16_f16 v[40:55], v[120:123], v[16:19], v[40:55]
  v_pk_mul_f16 v14, v35, v22 op_sel:[1,0] op_sel_hi:[1,1]
  v_pk_mul_f16 v15, v35, v23 op_sel:[1,0] op_sel_hi:[1,1]
  v_fmac_f32_e64 v4, v73, v89
  v_mfma_f32_32x32x16_f16 v[56:71], v[188:191], v[16:19], v[56:71]
  v_pk_mul_f16 v16, v35, v24 op_sel:[0,0] op_sel_hi:[0,1]
  v_pk_mul_f16 v17, v35, v25 op_sel:[0,0] op_sel_hi:[0,1]
  v_mfma_f32_32x32x16_f16 v[40:55], v[124:127], v[12:15], v[40:55]
  v_pk_mul_f16 v18, v35, v24 op_sel:[1,0] op_sel_hi:[1,1]
  v_fmac_f32 v4, v74, v90
  v_fmac_f32 v4, v75, v91
  v_mfma_f32_32x32x16_f16 v[56:71], v[192:195], v[12:15], v[56:71]
  v_pk_mul_f16 v19, v35, v25 op_sel:[1,0] op_sel_hi:[1,1]
  v_pk_mul_f16 v12, v39, v20 op_sel:[0,0] op_sel_hi:[0,1]
  v_pk_mul_f16 v13, v39, v21 op_sel:[0,0] op_sel_hi:[0,1]
  v_mfma_f32_32x32x16_f16 v[56:71], v[248:251], v[32:35], v[56:71]
  v_pk_mul_f16 v14, v39, v22 op_sel:[0,0] op_sel_hi:[0,1]
  v_fmac_f32 v4, v76, v92
  s_waitcnt lgkmcnt(1)
  v_mfma_f32_32x32x16_f16 v[40:55], v[104:107], v[16:19], v[40:55]
  v_pk_mul_f16 v15, v39, v23 op_sel:[0,0] op_sel_hi:[0,1]
  ds_read_b128 v[104:107], v0 offset:240
  v_fmac_f32_e64 v4, v77, v93
  v_mfma_f32_32x32x16_f16 v[56:71], v[108:111], v[16:19], v[56:71]
  v_pk_mul_f16 v16, v39, v24 op_sel:[0,0] op_sel_hi:[0,1]
  v_pk_mul_f16 v17, v39, v25 op_sel:[0,0] op_sel_hi:[0,1]
  ds_read_b128 v[108:111], v0 offset:21456
  v_mfma_f32_32x32x16_f16 v[40:55], v[152:155], v[12:15], v[40:55]
  v_pk_mul_f16 v18, v39, v26 op_sel:[0,0] op_sel_hi:[0,1]
  v_pk_mul_f16 v19, v39, v27 op_sel:[0,0] op_sel_hi:[0,1]
  v_fmac_f32_e64 v4, v78, v94
  v_mfma_f32_32x32x16_f16 v[56:71], v[220:223], v[12:15], v[56:71]
  v_pk_mul_f16 v12, v32, v21 op_sel:[0,0] op_sel_hi:[0,1]
  v_pk_mul_f16 v13, v34, v25 op_sel:[0,0] op_sel_hi:[0,1]
  v_fmac_f32_e64 v4, v79, v95
  v_mfma_f32_32x32x16_f16 v[40:55], v[156:159], v[16:19], v[40:55]
  v_pk_mul_f16 v14, v36, v29 op_sel:[0,0] op_sel_hi:[0,1]
  v_pk_mul_f16 v15, v39, v38 op_sel:[0,0] op_sel_hi:[0,1]
  v_fmac_f32 v4, v80, v96
  v_fmac_f32 v4, v81, v97
  v_mfma_f32_32x32x16_f16 v[56:71], v[224:227], v[16:19], v[56:71]
  v_pk_mul_f16 v16, v32, v32
  v_pk_mul_f16 v17, v33, v33
  v_pk_mul_f16 v18, v33, v23 op_sel:[0,0] op_sel_hi:[0,1]
  v_fmac_f32_e64 v4, v82, v98
  v_mfma_f32_32x32x16_f16 v[40:55], v[176:179], v[12:15], v[40:55]
  v_permlane32_swap_b32_e64 v32, v33
  v_pk_mul_f16 v19, v32, v33
  s_waitcnt lgkmcnt(2)
  s_nop 0
  v_xor_b32_sdwa v11, v1, v6 dst_sel:DWORD dst_unused:UNUSED_PAD src0_sel:DWORD src1_sel:WORD_0
  ds_read_b64_tr_b16 v[32:33], v11 offset:42208
  v_mfma_f32_32x32x16_f16 v[56:71], v[244:247], v[12:15], v[56:71]
  v_pk_mul_f16 v12, v34, v34
  v_pk_mul_f16 v13, v35, v35
  v_pk_mul_f16 v14, v35, v27 op_sel:[0,0] op_sel_hi:[0,1]
  v_fmac_f32_e64 v4, v83, v99
  v_mfma_f32_32x32x16_f16 v[40:55], v[164:167], v[16:19], v[40:55]
  v_permlane32_swap_b32_e64 v34, v35
  v_pk_mul_f16 v15, v34, v35
  v_xor_b32_sdwa v11, v1, v6 dst_sel:DWORD dst_unused:UNUSED_PAD src0_sel:DWORD src1_sel:WORD_1
  ds_read_b64_tr_b16 v[34:35], v11 offset:42208
  v_mfma_f32_32x32x16_f16 v[56:71], v[232:235], v[16:19], v[56:71]
  v_pk_mul_f16 v16, v37, v20 op_sel:[0,0] op_sel_hi:[0,1]
  v_pk_mul_f16 v17, v37, v21 op_sel:[0,0] op_sel_hi:[0,1]
  v_fmac_f32_e64 v4, v84, v100
  v_mfma_f32_32x32x16_f16 v[40:55], v[168:171], v[12:15], v[40:55]
  v_pk_mul_f16 v18, v37, v20 op_sel:[1,0] op_sel_hi:[1,1]
  v_pk_mul_f16 v19, v37, v21 op_sel:[1,0] op_sel_hi:[1,1]
  ds_write_b32 v5, v4 offset:0
  v_mfma_f32_32x32x16_f16 v[56:71], v[236:239], v[12:15], v[56:71]
  v_pk_mul_f16 v12, v36, v20 op_sel:[0,0] op_sel_hi:[0,1]
  v_pk_mul_f16 v13, v36, v21 op_sel:[0,0] op_sel_hi:[0,1]
  s_waitcnt lgkmcnt(3)
  s_nop 0
  v_mfma_f32_32x32x16_f16 v[40:55], v[104:107], v[16:19], v[40:55]
  v_pk_mul_f16 v14, v36, v20 op_sel:[1,0] op_sel_hi:[1,1]
  v_pk_mul_f16 v15, v36, v21 op_sel:[1,0] op_sel_hi:[1,1]
  ds_read_b128 v[104:107], v0 offset:272
  v_mfma_f32_32x32x16_f16 v[56:71], v[108:111], v[16:19], v[56:71]
  v_pk_mul_f16 v16, v36, v22 op_sel:[0,0] op_sel_hi:[0,1]
  v_pk_mul_f16 v17, v36, v23 op_sel:[0,0] op_sel_hi:[0,1]
  ds_read_b128 v[108:111], v0 offset:21488
  v_mfma_f32_32x32x16_f16 v[40:55], v[128:131], v[12:15], v[40:55]
  v_pk_mul_f16 v18, v36, v22 op_sel:[1,0] op_sel_hi:[1,1]
  v_pk_mul_f16 v19, v36, v23 op_sel:[1,0] op_sel_hi:[1,1]
  v_xor_b32_sdwa v11, v1, v8 dst_sel:DWORD dst_unused:UNUSED_PAD src0_sel:DWORD src1_sel:WORD_0
  ds_read_b64_tr_b16 v[20:21], v11 offset:42208
  v_mfma_f32_32x32x16_f16 v[56:71], v[196:199], v[12:15], v[56:71]
  v_pk_mul_f16 v12, v37, v22 op_sel:[0,0] op_sel_hi:[0,1]
  v_pk_mul_f16 v13, v37, v23 op_sel:[0,0] op_sel_hi:[0,1]
  v_mfma_f32_32x32x16_f16 v[40:55], v[132:135], v[16:19], v[40:55]
  v_pk_mul_f16 v14, v37, v22 op_sel:[1,0] op_sel_hi:[1,1]
  v_pk_mul_f16 v15, v37, v23 op_sel:[1,0] op_sel_hi:[1,1]
  v_xor_b32_sdwa v11, v1, v8 dst_sel:DWORD dst_unused:UNUSED_PAD src0_sel:DWORD src1_sel:WORD_1
  ds_read_b64_tr_b16 v[22:23], v11 offset:42208
  v_mfma_f32_32x32x16_f16 v[56:71], v[200:203], v[16:19], v[56:71]
  v_pk_mul_f16 v16, v37, v24 op_sel:[0,0] op_sel_hi:[0,1]
  v_pk_mul_f16 v17, v37, v25 op_sel:[0,0] op_sel_hi:[0,1]
  v_mfma_f32_32x32x16_f16 v[40:55], v[144:147], v[12:15], v[40:55]
  v_pk_mul_f16 v18, v37, v24 op_sel:[1,0] op_sel_hi:[1,1]
  v_pk_mul_f16 v19, v37, v25 op_sel:[1,0] op_sel_hi:[1,1]
  v_mfma_f32_32x32x16_f16 v[56:71], v[212:215], v[12:15], v[56:71]
  v_pk_mul_f16 v12, v36, v24 op_sel:[0,0] op_sel_hi:[0,1]
  v_pk_mul_f16 v13, v36, v25 op_sel:[0,0] op_sel_hi:[0,1]
  s_waitcnt lgkmcnt(2)
  s_nop 0
  v_mfma_f32_32x32x16_f16 v[40:55], v[104:107], v[16:19], v[40:55]
  v_pk_mul_f16 v14, v36, v24 op_sel:[1,0] op_sel_hi:[1,1]
  v_pk_mul_f16 v15, v36, v25 op_sel:[1,0] op_sel_hi:[1,1]
  ds_read_b128 v[104:107], v0 offset:288
  v_mfma_f32_32x32x16_f16 v[56:71], v[108:111], v[16:19], v[56:71]
  v_pk_mul_f16 v16, v39, v28 op_sel:[0,0] op_sel_hi:[0,1]
  v_pk_mul_f16 v17, v39, v29 op_sel:[0,0] op_sel_hi:[0,1]
  ds_read_b128 v[108:111], v0 offset:21504
  v_mfma_f32_32x32x16_f16 v[40:55], v[136:139], v[12:15], v[40:55]
  v_pk_mul_f16 v18, v39, v30 op_sel:[0,0] op_sel_hi:[0,1]
  v_xor_b32_sdwa v11, v1, v9 dst_sel:DWORD dst_unused:UNUSED_PAD src0_sel:DWORD src1_sel:WORD_0
  ds_read_b64_tr_b16 v[24:25], v11 offset:42208
  v_mfma_f32_32x32x16_f16 v[56:71], v[204:207], v[12:15], v[56:71]
  v_pk_mul_f16 v19, v39, v31 op_sel:[0,0] op_sel_hi:[0,1]
  v_pk_mul_f16 v12, v36, v26 op_sel:[0,0] op_sel_hi:[0,1]
  v_pk_mul_f16 v13, v36, v27 op_sel:[0,0] op_sel_hi:[0,1]
  v_mfma_f32_32x32x16_f16 v[56:71], v[252:255], v[36:39], v[56:71]
  v_pk_mul_f16 v14, v36, v26 op_sel:[1,0] op_sel_hi:[1,1]
  v_xor_b32_sdwa v11, v1, v7 dst_sel:DWORD dst_unused:UNUSED_PAD src0_sel:DWORD src1_sel:WORD_1
  ds_read_b64_tr_b16 v[38:39], v11 offset:42208
  v_mfma_f32_32x32x16_f16 v[40:55], v[160:163], v[16:19], v[40:55]
  v_pk_mul_f16 v15, v36, v27 op_sel:[1,0] op_sel_hi:[1,1]
  v_mfma_f32_32x32x16_f16 v[56:71], v[228:231], v[16:19], v[56:71]
  v_pk_mul_f16 v16, v37, v26 op_sel:[0,0] op_sel_hi:[0,1]
  v_pk_mul_f16 v17, v37, v27 op_sel:[0,0] op_sel_hi:[0,1]
  v_mfma_f32_32x32x16_f16 v[40:55], v[140:143], v[12:15], v[40:55]
  v_pk_mul_f16 v18, v37, v26 op_sel:[1,0] op_sel_hi:[1,1]
  v_pk_mul_f16 v19, v37, v27 op_sel:[1,0] op_sel_hi:[1,1]
  v_xor_b32_sdwa v11, v1, v9 dst_sel:DWORD dst_unused:UNUSED_PAD src0_sel:DWORD src1_sel:WORD_1
  ds_read_b64_tr_b16 v[26:27], v11 offset:42208
  v_mfma_f32_32x32x16_f16 v[56:71], v[208:211], v[12:15], v[56:71]
  v_pk_mul_f16 v12, v37, v28 op_sel:[0,0] op_sel_hi:[0,1]
  v_pk_mul_f16 v13, v37, v29 op_sel:[0,0] op_sel_hi:[0,1]
  s_waitcnt lgkmcnt(3)
  s_nop 0
  v_mfma_f32_32x32x16_f16 v[40:55], v[104:107], v[16:19], v[40:55]
  v_pk_mul_f16 v14, v37, v28 op_sel:[1,0] op_sel_hi:[1,1]
  v_pk_mul_f16 v15, v37, v29 op_sel:[1,0] op_sel_hi:[1,1]
  ds_read_b128 v[104:107], v0 offset:96
  v_mfma_f32_32x32x16_f16 v[56:71], v[108:111], v[16:19], v[56:71]
  v_pk_mul_f16 v16, v36, v36
  v_pk_mul_f16 v17, v37, v37
  v_pk_mul_f16 v18, v37, v31 op_sel:[0,0] op_sel_hi:[0,1]
  ds_read_b128 v[108:111], v0 offset:21312
  v_mfma_f32_32x32x16_f16 v[40:55], v[148:151], v[12:15], v[40:55]
  v_permlane32_swap_b32_e64 v36, v37
  v_pk_mul_f16 v19, v36, v37
  v_xor_b32_sdwa v11, v1, v7 dst_sel:DWORD dst_unused:UNUSED_PAD src0_sel:DWORD src1_sel:WORD_0
  ds_read_b64_tr_b16 v[36:37], v11 offset:42208
  v_mfma_f32_32x32x16_f16 v[56:71], v[216:219], v[12:15], v[56:71]
  v_pk_mul_f16 v12, v34, v20 op_sel:[0,0] op_sel_hi:[0,1]
  v_pk_mul_f16 v13, v34, v21 op_sel:[0,0] op_sel_hi:[0,1]
  v_xor_b32_sdwa v11, v1, v10 dst_sel:DWORD dst_unused:UNUSED_PAD src0_sel:DWORD src1_sel:WORD_1
  ds_read_b64_tr_b16 v[30:31], v11 offset:42208
  v_mfma_f32_32x32x16_f16 v[40:55], v[172:175], v[16:19], v[40:55]
  v_pk_mul_f16 v14, v34, v20 op_sel:[1,0] op_sel_hi:[1,1]
  v_pk_mul_f16 v15, v34, v21 op_sel:[1,0] op_sel_hi:[1,1]
  v_xor_b32_sdwa v11, v1, v10 dst_sel:DWORD dst_unused:UNUSED_PAD src0_sel:DWORD src1_sel:WORD_0
  ds_read_b64_tr_b16 v[28:29], v11 offset:42208
  v_mfma_f32_32x32x16_f16 v[56:71], v[240:243], v[16:19], v[56:71]
  v_pk_mul_f16 v16, v35, v20 op_sel:[0,0] op_sel_hi:[0,1]
  v_pk_mul_f16 v17, v35, v21 op_sel:[0,0] op_sel_hi:[0,1]
  v_mfma_f32_32x32x16_f16 v[72:87], v[116:119], v[12:15], 0
  v_pk_mul_f16 v18, v35, v20 op_sel:[1,0] op_sel_hi:[1,1]
  v_pk_mul_f16 v19, v35, v21 op_sel:[1,0] op_sel_hi:[1,1]
  ds_read_b96 v[8:10], v2 offset:576
  v_mfma_f32_32x32x16_f16 v[88:103], v[184:187], v[12:15], 0
  v_pk_mul_f16 v12, v33, v20 op_sel:[0,0] op_sel_hi:[0,1]
  v_pk_mul_f16 v13, v33, v21 op_sel:[0,0] op_sel_hi:[0,1]
  s_waitcnt lgkmcnt(4)
  s_nop 0
  v_mfma_f32_32x32x16_f16 v[72:87], v[104:107], v[16:19], v[72:87]
  v_pk_mul_f16 v14, v33, v20 op_sel:[1,0] op_sel_hi:[1,1]
  v_pk_mul_f16 v15, v33, v21 op_sel:[1,0] op_sel_hi:[1,1]
  ds_read_b128 v[104:107], v0 offset:128
  v_mfma_f32_32x32x16_f16 v[88:103], v[108:111], v[16:19], v[88:103]
  v_pk_mul_f16 v16, v34, v22 op_sel:[0,0] op_sel_hi:[0,1]
  v_pk_mul_f16 v17, v34, v23 op_sel:[0,0] op_sel_hi:[0,1]
  ds_read_b128 v[108:111], v0 offset:21344
  v_mfma_f32_32x32x16_f16 v[72:87], v[112:115], v[12:15], v[72:87]
  v_pk_mul_f16 v18, v34, v22 op_sel:[1,0] op_sel_hi:[1,1]
  v_pk_mul_f16 v19, v34, v23 op_sel:[1,0] op_sel_hi:[1,1]
  ds_read_b64 v[6:7], v3 offset:640
  v_mfma_f32_32x32x16_f16 v[88:103], v[180:183], v[12:15], v[88:103]
  v_pk_mul_f16 v12, v35, v22 op_sel:[0,0] op_sel_hi:[0,1]
  v_pk_mul_f16 v13, v35, v23 op_sel:[0,0] op_sel_hi:[0,1]
  v_mul_f32_e64 v4, v40, v56
  v_mfma_f32_32x32x16_f16 v[72:87], v[120:123], v[16:19], v[72:87]
  v_pk_mul_f16 v14, v35, v22 op_sel:[1,0] op_sel_hi:[1,1]
  v_pk_mul_f16 v15, v35, v23 op_sel:[1,0] op_sel_hi:[1,1]
  v_fmac_f32_e64 v4, v41, v57
  v_mfma_f32_32x32x16_f16 v[88:103], v[188:191], v[16:19], v[88:103]
  v_pk_mul_f16 v16, v35, v24 op_sel:[0,0] op_sel_hi:[0,1]
  v_pk_mul_f16 v17, v35, v25 op_sel:[0,0] op_sel_hi:[0,1]
  v_mfma_f32_32x32x16_f16 v[72:87], v[124:127], v[12:15], v[72:87]
  v_pk_mul_f16 v18, v35, v24 op_sel:[1,0] op_sel_hi:[1,1]
  v_fmac_f32 v4, v42, v58
  v_fmac_f32 v4, v43, v59
  v_mfma_f32_32x32x16_f16 v[88:103], v[192:195], v[12:15], v[88:103]
  v_pk_mul_f16 v19, v35, v25 op_sel:[1,0] op_sel_hi:[1,1]
  v_pk_mul_f16 v12, v39, v20 op_sel:[0,0] op_sel_hi:[0,1]
  v_pk_mul_f16 v13, v39, v21 op_sel:[0,0] op_sel_hi:[0,1]
  v_mfma_f32_32x32x16_f16 v[88:103], v[248:251], v[32:35], v[88:103]
  v_pk_mul_f16 v14, v39, v22 op_sel:[0,0] op_sel_hi:[0,1]
  v_fmac_f32 v4, v44, v60
  s_waitcnt lgkmcnt(1)
  v_mfma_f32_32x32x16_f16 v[72:87], v[104:107], v[16:19], v[72:87]
  v_pk_mul_f16 v15, v39, v23 op_sel:[0,0] op_sel_hi:[0,1]
  ds_read_b128 v[104:107], v0 offset:240
  v_fmac_f32_e64 v4, v45, v61
  v_mfma_f32_32x32x16_f16 v[88:103], v[108:111], v[16:19], v[88:103]
  v_pk_mul_f16 v16, v39, v24 op_sel:[0,0] op_sel_hi:[0,1]
  v_pk_mul_f16 v17, v39, v25 op_sel:[0,0] op_sel_hi:[0,1]
  ds_read_b128 v[108:111], v0 offset:21456
  v_mfma_f32_32x32x16_f16 v[72:87], v[152:155], v[12:15], v[72:87]
  v_pk_mul_f16 v18, v39, v26 op_sel:[0,0] op_sel_hi:[0,1]
  v_pk_mul_f16 v19, v39, v27 op_sel:[0,0] op_sel_hi:[0,1]
  v_fmac_f32_e64 v4, v46, v62
  v_mfma_f32_32x32x16_f16 v[88:103], v[220:223], v[12:15], v[88:103]
  v_pk_mul_f16 v12, v32, v21 op_sel:[0,0] op_sel_hi:[0,1]
  v_pk_mul_f16 v13, v34, v25 op_sel:[0,0] op_sel_hi:[0,1]
  v_fmac_f32_e64 v4, v47, v63
  v_mfma_f32_32x32x16_f16 v[72:87], v[156:159], v[16:19], v[72:87]
  v_pk_mul_f16 v14, v36, v29 op_sel:[0,0] op_sel_hi:[0,1]
  v_pk_mul_f16 v15, v39, v38 op_sel:[0,0] op_sel_hi:[0,1]
  v_fmac_f32 v4, v48, v64
  v_fmac_f32 v4, v49, v65
  v_mfma_f32_32x32x16_f16 v[88:103], v[224:227], v[16:19], v[88:103]
  v_pk_mul_f16 v16, v32, v32
  v_pk_mul_f16 v17, v33, v33
  v_pk_mul_f16 v18, v33, v23 op_sel:[0,0] op_sel_hi:[0,1]
  v_fmac_f32_e64 v4, v50, v66
  v_mfma_f32_32x32x16_f16 v[72:87], v[176:179], v[12:15], v[72:87]
  v_permlane32_swap_b32_e64 v32, v33
  v_pk_mul_f16 v19, v32, v33
  s_waitcnt lgkmcnt(2)
  s_nop 0
  v_xor_b32_sdwa v11, v1, v6 dst_sel:DWORD dst_unused:UNUSED_PAD src0_sel:DWORD src1_sel:WORD_0
  ds_read_b64_tr_b16 v[32:33], v11 offset:42208
  v_mfma_f32_32x32x16_f16 v[88:103], v[244:247], v[12:15], v[88:103]
  v_pk_mul_f16 v12, v34, v34
  v_pk_mul_f16 v13, v35, v35
  v_pk_mul_f16 v14, v35, v27 op_sel:[0,0] op_sel_hi:[0,1]
  v_fmac_f32_e64 v4, v51, v67
  v_mfma_f32_32x32x16_f16 v[72:87], v[164:167], v[16:19], v[72:87]
  v_permlane32_swap_b32_e64 v34, v35
  v_pk_mul_f16 v15, v34, v35
  v_xor_b32_sdwa v11, v1, v6 dst_sel:DWORD dst_unused:UNUSED_PAD src0_sel:DWORD src1_sel:WORD_1
  ds_read_b64_tr_b16 v[34:35], v11 offset:42208
  v_mfma_f32_32x32x16_f16 v[88:103], v[232:235], v[16:19], v[88:103]
  v_pk_mul_f16 v16, v37, v20 op_sel:[0,0] op_sel_hi:[0,1]
  v_pk_mul_f16 v17, v37, v21 op_sel:[0,0] op_sel_hi:[0,1]
  v_fmac_f32_e64 v4, v52, v68
  v_mfma_f32_32x32x16_f16 v[72:87], v[168:171], v[12:15], v[72:87]
  v_pk_mul_f16 v18, v37, v20 op_sel:[1,0] op_sel_hi:[1,1]
  v_pk_mul_f16 v19, v37, v21 op_sel:[1,0] op_sel_hi:[1,1]
  ds_write_b32 v5, v4 offset:288
  v_mfma_f32_32x32x16_f16 v[88:103], v[236:239], v[12:15], v[88:103]
  v_pk_mul_f16 v12, v36, v20 op_sel:[0,0] op_sel_hi:[0,1]
  v_pk_mul_f16 v13, v36, v21 op_sel:[0,0] op_sel_hi:[0,1]
  s_waitcnt lgkmcnt(3)
  s_nop 0
  v_mfma_f32_32x32x16_f16 v[72:87], v[104:107], v[16:19], v[72:87]
  v_pk_mul_f16 v14, v36, v20 op_sel:[1,0] op_sel_hi:[1,1]
  v_pk_mul_f16 v15, v36, v21 op_sel:[1,0] op_sel_hi:[1,1]
  ds_read_b128 v[104:107], v0 offset:272
  v_mfma_f32_32x32x16_f16 v[88:103], v[108:111], v[16:19], v[88:103]
  v_pk_mul_f16 v16, v36, v22 op_sel:[0,0] op_sel_hi:[0,1]
  v_pk_mul_f16 v17, v36, v23 op_sel:[0,0] op_sel_hi:[0,1]
  ds_read_b128 v[108:111], v0 offset:21488
  v_mfma_f32_32x32x16_f16 v[72:87], v[128:131], v[12:15], v[72:87]
  v_pk_mul_f16 v18, v36, v22 op_sel:[1,0] op_sel_hi:[1,1]
  v_pk_mul_f16 v19, v36, v23 op_sel:[1,0] op_sel_hi:[1,1]
  v_xor_b32_sdwa v11, v1, v8 dst_sel:DWORD dst_unused:UNUSED_PAD src0_sel:DWORD src1_sel:WORD_0
  ds_read_b64_tr_b16 v[20:21], v11 offset:42208
  v_mfma_f32_32x32x16_f16 v[88:103], v[196:199], v[12:15], v[88:103]
  v_pk_mul_f16 v12, v37, v22 op_sel:[0,0] op_sel_hi:[0,1]
  v_pk_mul_f16 v13, v37, v23 op_sel:[0,0] op_sel_hi:[0,1]
  v_mfma_f32_32x32x16_f16 v[72:87], v[132:135], v[16:19], v[72:87]
  v_pk_mul_f16 v14, v37, v22 op_sel:[1,0] op_sel_hi:[1,1]
  v_pk_mul_f16 v15, v37, v23 op_sel:[1,0] op_sel_hi:[1,1]
  v_xor_b32_sdwa v11, v1, v8 dst_sel:DWORD dst_unused:UNUSED_PAD src0_sel:DWORD src1_sel:WORD_1
  ds_read_b64_tr_b16 v[22:23], v11 offset:42208
  v_mfma_f32_32x32x16_f16 v[88:103], v[200:203], v[16:19], v[88:103]
  v_add_u32 v2, s9, v2
  v_add_u32 v3, s9, v3
  v_pk_mul_f16 v16, v37, v24 op_sel:[0,0] op_sel_hi:[0,1]
  v_pk_mul_f16 v17, v37, v25 op_sel:[0,0] op_sel_hi:[0,1]
  v_mfma_f32_32x32x16_f16 v[72:87], v[144:147], v[12:15], v[72:87]
  v_pk_mul_f16 v18, v37, v24 op_sel:[1,0] op_sel_hi:[1,1]
  v_pk_mul_f16 v19, v37, v25 op_sel:[1,0] op_sel_hi:[1,1]
  v_mfma_f32_32x32x16_f16 v[88:103], v[212:215], v[12:15], v[88:103]
  v_pk_mul_f16 v12, v36, v24 op_sel:[0,0] op_sel_hi:[0,1]
  v_pk_mul_f16 v13, v36, v25 op_sel:[0,0] op_sel_hi:[0,1]
  s_waitcnt lgkmcnt(2)
  s_nop 0
  v_mfma_f32_32x32x16_f16 v[72:87], v[104:107], v[16:19], v[72:87]
  v_pk_mul_f16 v14, v36, v24 op_sel:[1,0] op_sel_hi:[1,1]
  v_pk_mul_f16 v15, v36, v25 op_sel:[1,0] op_sel_hi:[1,1]
  ds_read_b128 v[104:107], v0 offset:288
  v_mfma_f32_32x32x16_f16 v[88:103], v[108:111], v[16:19], v[88:103]
  v_pk_mul_f16 v16, v39, v28 op_sel:[0,0] op_sel_hi:[0,1]
  v_pk_mul_f16 v17, v39, v29 op_sel:[0,0] op_sel_hi:[0,1]
  ds_read_b128 v[108:111], v0 offset:21504
  v_mfma_f32_32x32x16_f16 v[72:87], v[136:139], v[12:15], v[72:87]
  v_pk_mul_f16 v18, v39, v30 op_sel:[0,0] op_sel_hi:[0,1]
  v_xor_b32_sdwa v11, v1, v9 dst_sel:DWORD dst_unused:UNUSED_PAD src0_sel:DWORD src1_sel:WORD_0
  ds_read_b64_tr_b16 v[24:25], v11 offset:42208
  v_mfma_f32_32x32x16_f16 v[88:103], v[204:207], v[12:15], v[88:103]
  v_pk_mul_f16 v19, v39, v31 op_sel:[0,0] op_sel_hi:[0,1]
  v_pk_mul_f16 v12, v36, v26 op_sel:[0,0] op_sel_hi:[0,1]
  v_pk_mul_f16 v13, v36, v27 op_sel:[0,0] op_sel_hi:[0,1]
  v_mfma_f32_32x32x16_f16 v[88:103], v[252:255], v[36:39], v[88:103]
  v_pk_mul_f16 v14, v36, v26 op_sel:[1,0] op_sel_hi:[1,1]
  v_xor_b32_sdwa v11, v1, v7 dst_sel:DWORD dst_unused:UNUSED_PAD src0_sel:DWORD src1_sel:WORD_1
  ds_read_b64_tr_b16 v[38:39], v11 offset:42208
  v_mfma_f32_32x32x16_f16 v[72:87], v[160:163], v[16:19], v[72:87]
  v_add_u32 v5, s9, v5
  s_add_u32 s8, s8, 1
  v_pk_mul_f16 v15, v36, v27 op_sel:[1,0] op_sel_hi:[1,1]
  v_mfma_f32_32x32x16_f16 v[88:103], v[228:231], v[16:19], v[88:103]
  v_pk_mul_f16 v16, v37, v26 op_sel:[0,0] op_sel_hi:[0,1]
  v_pk_mul_f16 v17, v37, v27 op_sel:[0,0] op_sel_hi:[0,1]
  v_mfma_f32_32x32x16_f16 v[72:87], v[140:143], v[12:15], v[72:87]
  v_pk_mul_f16 v18, v37, v26 op_sel:[1,0] op_sel_hi:[1,1]
  v_pk_mul_f16 v19, v37, v27 op_sel:[1,0] op_sel_hi:[1,1]
  v_xor_b32_sdwa v11, v1, v9 dst_sel:DWORD dst_unused:UNUSED_PAD src0_sel:DWORD src1_sel:WORD_1
  ds_read_b64_tr_b16 v[26:27], v11 offset:42208
  v_mfma_f32_32x32x16_f16 v[88:103], v[208:211], v[12:15], v[88:103]
  v_pk_mul_f16 v12, v37, v28 op_sel:[0,0] op_sel_hi:[0,1]
  v_pk_mul_f16 v13, v37, v29 op_sel:[0,0] op_sel_hi:[0,1]
  s_waitcnt lgkmcnt(3)
  s_nop 0
  v_mfma_f32_32x32x16_f16 v[72:87], v[104:107], v[16:19], v[72:87]
  v_pk_mul_f16 v14, v37, v28 op_sel:[1,0] op_sel_hi:[1,1]
  v_pk_mul_f16 v15, v37, v29 op_sel:[1,0] op_sel_hi:[1,1]
  ds_read_b128 v[104:107], v0 offset:96
  v_mfma_f32_32x32x16_f16 v[88:103], v[108:111], v[16:19], v[88:103]
  v_pk_mul_f16 v16, v36, v36
  v_pk_mul_f16 v17, v37, v37
  v_pk_mul_f16 v18, v37, v31 op_sel:[0,0] op_sel_hi:[0,1]
  ds_read_b128 v[108:111], v0 offset:21312
  v_mfma_f32_32x32x16_f16 v[72:87], v[148:151], v[12:15], v[72:87]
  v_permlane32_swap_b32_e64 v36, v37
  v_pk_mul_f16 v19, v36, v37
  v_xor_b32_sdwa v11, v1, v7 dst_sel:DWORD dst_unused:UNUSED_PAD src0_sel:DWORD src1_sel:WORD_0
  ds_read_b64_tr_b16 v[36:37], v11 offset:42208
  v_mfma_f32_32x32x16_f16 v[88:103], v[216:219], v[12:15], v[88:103]
  v_pk_mul_f16 v12, v34, v20 op_sel:[0,0] op_sel_hi:[0,1]
  v_pk_mul_f16 v13, v34, v21 op_sel:[0,0] op_sel_hi:[0,1]
  v_xor_b32_sdwa v11, v1, v10 dst_sel:DWORD dst_unused:UNUSED_PAD src0_sel:DWORD src1_sel:WORD_1
  ds_read_b64_tr_b16 v[30:31], v11 offset:42208
  v_mfma_f32_32x32x16_f16 v[72:87], v[172:175], v[16:19], v[72:87]
  v_pk_mul_f16 v14, v34, v20 op_sel:[1,0] op_sel_hi:[1,1]
  v_pk_mul_f16 v15, v34, v21 op_sel:[1,0] op_sel_hi:[1,1]
  v_xor_b32_sdwa v11, v1, v10 dst_sel:DWORD dst_unused:UNUSED_PAD src0_sel:DWORD src1_sel:WORD_0
  ds_read_b64_tr_b16 v[28:29], v11 offset:42208
  v_mfma_f32_32x32x16_f16 v[88:103], v[240:243], v[16:19], v[88:103]
  s_cmp_lt_u32 s8, 4
  s_nop 0
  v_pk_mul_f16 v16, v35, v20 op_sel:[0,0] op_sel_hi:[0,1]
  v_pk_mul_f16 v17, v35, v21 op_sel:[0,0] op_sel_hi:[0,1]
  s_cbranch_scc1 CLOOP
  v_mbcnt_lo_u32_b32 v0, -1, 0
  v_mbcnt_hi_u32_b32 v0, -1, v0
  v_mov_b32 v8, 0
  ds_read_b128 v[12:15], v8 offset:42144
  v_and_b32 v1, 15, v0
  v_lshrrev_b32 v2, 4, v0
  v_add_u32 v5, -2304, v5
  s_lshl_b32 s8, s3, 4
  v_add_u32 v6, s8, v1
  v_lshrrev_b32 v7, 5, v6
  v_lshlrev_b32 v7, 8, v7
  v_and_b32 v9, 31, v6
  v_lshl_add_u32 v7, v9, 2, v7
  v_mul_u32_u24 v9, 10240, v2
  v_add_u32 v7, v7, v9
  v_add_u32 v7, 127552, v7
  v_mul_f32 v4, v72, v88
  v_fmac_f32 v4, v73, v89
  v_fmac_f32 v4, v74, v90
  v_fmac_f32 v4, v75, v91
  v_fmac_f32 v4, v76, v92
  v_fmac_f32 v4, v77, v93
  v_fmac_f32 v4, v78, v94
  v_fmac_f32 v4, v79, v95
  v_fmac_f32 v4, v80, v96
  v_fmac_f32 v4, v81, v97
  v_fmac_f32 v4, v82, v98
  v_fmac_f32 v4, v83, v99
  v_fmac_f32 v4, v84, v100
  ds_write_b32 v5, v4
  v_add_u32 v3, 2, v1
  v_and_b32 v3, 14, v3
  v_mul_u32_u24 v3, 144, v3
  v_and_b32 v9, 1, v1
  v_lshl_add_u32 v3, v9, 6, v3
  v_lshrrev_b32 v9, 1, v2
  v_lshl_add_u32 v3, v9, 7, v3
  v_and_b32 v9, 1, v2
  v_lshl_add_u32 v3, v9, 5, v3
  s_mul_i32 s8, s3, 2304
  v_add_u32 v3, s8, v3
  ds_read_b128 v[40:43], v3 offset:32768
  ds_read_b128 v[44:47], v3 offset:32784
  s_waitcnt lgkmcnt(3)
  v_min_u32 v16, v12, v13
  v_min3_u32 v16, v16, v14, v15
  s_lshl_b32 s8, s2, 6
  v_readfirstlane_b32 s90, v16
  s_cmp_lg_u32 s90, 0
  s_cbranch_scc1 DNNOK
  s_mov_b32 s91, 0x80000
  s_branch SW21_f
SW21:
  s_setprio 0
  s_sleep 1
SW21_f:
  ds_read_b128 v[12:15], v8 offset:42144
  s_sub_u32 s91, s91, 1
  s_cbranch_scc1 SW21_x
  s_waitcnt lgkmcnt(0)
  v_min_u32 v16, v12, v13
  v_min3_u32 v16, v16, v14, v15
  s_nop 0
  v_readfirstlane_b32 s90, v16
  s_cmp_eq_u32 s90, 0
  s_cbranch_scc1 SW21
SW21_x:
  s_setprio 1
DNNOK:
  ds_read2_b32 v[48:49], v7 offset1:32
  v_add_lshl_u32 v1, v6, s8, 1
  s_waitcnt lgkmcnt(1)
  v_add_f32 v40, v40, v41
  v_add_f32 v42, v42, v43
  v_add_f32 v44, v44, v45
  v_add_f32 v46, v46, v47
  v_add_f32 v40, v40, v42
  v_add_f32 v44, v44, v46
  v_add_f32 v40, v40, v44
  v_ldexp_f32 v40, v40, s81
  s_waitcnt lgkmcnt(0)
  v_add_f32 v48, v48, v49
  v_add_f32 v40, v40, v48
  v_mov_b32 v41, v40
  s_nop 1
  v_permlane32_swap_b32 v40, v41
  v_add_f32 v40, v40, v41
  v_mov_b32 v41, v40
  s_nop 1
  v_permlane16_swap_b32 v40, v41
  v_add_f32 v12, v40, v41
  v_add_f32 v12, s83, v12
  v_cvt_pk_bf16_f32 v12, v12, v12
  s_mov_b64 exec, 0xffff
  global_store_short v1, v12, s[32:33]
  s_endpgm
.section .rodata,"a"
.p2align 6
.amdhsa_kernel standalone__deep_cross_xdeepfm__recsys_kernel
  .amdhsa_next_free_vgpr 256
  .amdhsa_next_free_sgpr 102
  .amdhsa_accum_offset 256
  .amdhsa_group_segment_fixed_size 0
  .amdhsa_kernarg_size 88
  .amdhsa_user_sgpr_count 2
  .amdhsa_user_sgpr_kernarg_segment_ptr 1
  .amdhsa_system_sgpr_workgroup_id_x 1
.end_amdhsa_kernel
```
